```python
import torch

def _softmax(x, axis=-1):
    return torch.softmax(x, dim=axis)
def _gelu(x):
    return torch.nn.functional.gelu(x, approximate="tanh")
def _silu(x):
    return torch.nn.functional.silu(x)
def _sigmoid(x):
    return torch.sigmoid(x)
def _layernorm(x, axis=-1, eps=1e-5):
    m = x.mean(dim=axis, keepdim=True)
    v = x.var(dim=axis, keepdim=True, unbiased=False)
    return (x - m) / torch.sqrt(v + eps)
def _scatter_add(tgt, idx, src, axis=0):
    return tgt.clone().index_add_(axis, idx, src)
def _segment_sum(src, seg, n):
    out = torch.zeros((n,) + src.shape[1:], dtype=src.dtype)
    return out.index_add_(0, seg, src)
def _pad(x, pw):
    flat = tuple(v for pair in reversed(pw) for v in pair)
    return torch.nn.functional.pad(x, flat)

kernel_name = 'recurrent_scan__ssm_conv_s4__glu_gated_glu__prompt'

def setup_inputs():

    _w = (lambda a: (lambda t: t.to(torch.bfloat16) if t.is_floating_point() else t)(torch.as_tensor(a)))
    def _A_setup():
        B, L, D, N = 1, 2048, 448, 256
        A_re = -(lambda _x: torch.exp(torch.as_tensor(_x)))((lambda *s: torch.randn(*s, dtype=torch.bfloat16) * 6.4)(D, N))
        A_im = torch.pi * (lambda *s: torch.randn(*s, dtype=torch.bfloat16) * 0.05)(D, N)
        B_re = (lambda *s: torch.randn(*s, dtype=torch.bfloat16) * 0.05)(D, N)
        B_im = (lambda *s: torch.randn(*s, dtype=torch.bfloat16) * 0.05)(D, N)
        C_re = (lambda *s: torch.randn(*s, dtype=torch.bfloat16) * 0.05)(D, N)
        C_im = (lambda *s: torch.randn(*s, dtype=torch.bfloat16) * 0.05)(D, N)
        log_dt = (lambda *s: torch.randn(*s, dtype=torch.bfloat16) * 0.05)(D) * 0.5 - 4.0
        Dskip = (lambda *s: torch.randn(*s, dtype=torch.bfloat16) * 0.05)(D)
        return {
            "u": _w((lambda *s: torch.randn(*s, dtype=torch.bfloat16) * 0.05)(B, L, D)),
            "A_re": _w(A_re),
            "A_im": _w(A_im),
            "B_re": _w(B_re),
            "B_im": _w(B_im),
            "C_re": _w(C_re),
            "C_im": _w(C_im),
            "log_dt": _w(log_dt),
            "Dskip": _w(Dskip),
        }
    _A_in = _A_setup()

    def _B_setup():
        B, S, D, F = 1, 2048, 448, 1792
        return {
            "x": _w((lambda *s: torch.randn(*s, dtype=torch.bfloat16) * 0.05)(B, S, D)),
            "w_gate": _w((lambda *s: torch.randn(*s, dtype=torch.bfloat16) * 0.05)(D, F)),
            "w_up": _w((lambda *s: torch.randn(*s, dtype=torch.bfloat16) * 0.05)(D, F)),
            "w_down": _w((lambda *s: torch.randn(*s, dtype=torch.bfloat16) * 0.05)(F, D)),
        }
    _B_in = _B_setup()

    return {
        "A_u": _A_in["u"],
        "A_A_re": _A_in["A_re"],
        "A_A_im": _A_in["A_im"],
        "A_B_re": _A_in["B_re"],
        "A_B_im": _A_in["B_im"],
        "A_C_re": _A_in["C_re"],
        "A_C_im": _A_in["C_im"],
        "A_log_dt": _A_in["log_dt"],
        "A_Dskip": _A_in["Dskip"],
        "B_x": _B_in["x"],
        "B_w_gate": _B_in["w_gate"],
        "B_w_up": _B_in["w_up"],
        "B_w_down": _B_in["w_down"],
    }

def reference(A_u, A_A_re, A_A_im, A_B_re, A_B_im, A_C_re, A_C_im, A_log_dt, A_Dskip, B_x, B_w_gate, B_w_up, B_w_down):
    def _A_ref(u, A_re, A_im, B_re, B_im, C_re, C_im, log_dt, Dskip):
        Bsz, L, D = u.shape
        dt = torch.exp(log_dt)[:, None]
        A = A_re + 1j * A_im
        Bc = B_re + 1j * B_im
        Cc = C_re + 1j * C_im
        logdA = dt * A
        dB = dt * Bc
        l = (lambda x, dt: x.to(dt))(torch.arange(L), A_re.dtype)
        P = torch.exp(logdA[:, :, None] * l[None, None, :])
        K = torch.einsum("dn,dnl,dn->dl", Cc, P, dB).real
        L2 = 2 * L
        Kp = _pad(K, ((0, 0), (0, L)))
        up = (lambda x, *d: x.permute(*d))(u, 0, 2, 1)
        up = _pad(up, ((0, 0), (0, 0), (0, L)))
        Kf = (lambda x, axes=(-2,-1): torch.fft.rfft2(x.float(), dim=axes))(Kp[:, None, :], axes=(-2, -1))
        Uf = (lambda x, axes=(-2,-1): torch.fft.rfft2(x.float(), dim=axes))(up[:, :, None, :], axes=(-2, -1))
        Yf = Uf * Kf[None, :, :, :]
        y = (lambda x, s, axes=(-2,-1): torch.fft.irfft2(x, s=s, dim=axes).to(torch.bfloat16))(Yf, (1, L2), axes=(-2, -1))[:, :, 0, :L]
        y = (lambda x, *d: x.permute(*d))(y, 0, 2, 1) + u * Dskip[None, None, :]
        return y

    def _B_ref(x, w_gate, w_up, w_down):
        g = torch.einsum("bsd,df->bsf", x, w_gate)
        u = torch.einsum("bsd,df->bsf", x, w_up)
        h = _sigmoid(g) * u
        return torch.einsum("bsf,fd->bsd", h, w_down)

    x = A_u
    xn = _layernorm(x, axis=-1)
    s = _A_ref(xn, A_A_re, A_A_im, A_B_re, A_B_im, A_C_re, A_C_im, A_log_dt, A_Dskip)
    g = _silu(_B_ref(xn, B_w_gate, B_w_up, B_w_down))
    return x + s * g
```

```asm
; @launch grid=(256,1,1) block=(512,1,1) lds=163840
.amdgcn_target "amdgcn-amd-amdhsa--gfx950"
.text
.globl recurrent_scan__ssm_conv_s4__glu_gated_glu__prompt_kernel
.p2align 8
.type recurrent_scan__ssm_conv_s4__glu_gated_glu__prompt_kernel,@function
recurrent_scan__ssm_conv_s4__glu_gated_glu__prompt_kernel:
    s_cmp_ge_u32 s2, 256
    s_cbranch_scc1 Lend
    s_load_dwordx16 s[16:31], s[0:1], 0
    s_load_dwordx16 s[32:47], s[0:1], 64
    s_lshr_b32 s9, s2, 3
    s_getpc_b64 s[70:71]
Lpc:
    s_lshl_b32 s72, s9, 10
    v_lshlrev_b32 v2, 7, v0
    v_add_u32 v2, s72, v2
    v_min_u32 v2, Lend-Lpc, v2
    v_cmp_gt_u32 vcc, 8, v0
    s_nop 0
    s_and_saveexec_b64 s[72:73], vcc
    s_cbranch_execz Lnopf
    global_load_dword v255, v2, s[70:71]
Lnopf:
    s_mov_b64 exec, s[72:73]
    v_lshrrev_b32 v2, 6, v0
    v_and_b32 v1, 63, v0
    v_readfirstlane_b32 s3, v2
    s_and_b32 s8, s2, 7
    s_mul_i32 s10, s9, 37
    s_lshr_b32 s10, s10, 8
    s_mul_i32 s70, s10, 7
    s_sub_u32 s11, s9, s70
    s_lshr_b32 s70, s8, 2
    s_lshl_b32 s70, s70, 2
    s_add_u32 s12, s70, s10
    s_and_b32 s70, s8, 3
    s_mul_i32 s70, s70, 7
    s_add_u32 s13, s70, s11
    s_lshl_b32 s70, s8, 2
    s_add_u32 s14, s70, s10
    s_mul_i32 s70, s8, 28
    s_add_u32 s15, s70, s9
    v_lshlrev_b32 v3, 4, v1
    v_mov_b32 v10, 0
    v_mov_b32 v11, 0
    v_mov_b32 v12, 0
    v_mov_b32 v13, 0
    v_mov_b32 v4, 0
    s_lshl_b32 s77, s8, 5
    s_add_u32 s77, s77, s9
    s_lshl_b32 s77, s77, 3
    s_add_u32 s77, s77, s3
    s_mul_i32 s77, s77, 896
    v_lshrrev_b32 v5, 3, v1
    v_bfe_u32 v6, v1, 4, 1
    v_lshlrev_b32 v6, 2, v6
    v_and_b32 v7, 7, v1
    v_xor_b32 v6, v6, v7
    v_lshlrev_b32 v6, 4, v6
    s_lshr_b32 s71, s3, 2
    s_lshl_b32 s72, s15, 1
    s_add_u32 s71, s71, s72
    s_lshl_b32 s71, s71, 9
    s_and_b32 s72, s3, 3
    s_lshl_b32 s72, s72, 7
    s_add_u32 s71, s71, s72
    v_lshlrev_b32 v14, 1, v1
    v_add_u32 v14, s71, v14
    s_mul_i32 s73, s10, 14
    s_lshl_b32 s71, s3, 1
    s_add_u32 s73, s73, s71
    s_lshl_b32 s76, s13, 7
    s_nop 0
    s_mov_b32 s6, 0x2000000
    s_mov_b32 s7, 0x20000
    s_mov_b32 s50, 1835008
    s_mov_b32 s51, 0x20000
    s_mov_b32 s54, 1605632
    s_mov_b32 s55, 0x20000
    s_mov_b32 s58, 1605632
    s_mov_b32 s59, 0x20000
    s_mov_b32 s62, 1605632
    s_mov_b32 s63, 0x20000
    s_mov_b32 s66, 1835008
    s_mov_b32 s67, 0x20000
    s_waitcnt lgkmcnt(0)
    s_mov_b64 s[48:49], s[16:17]
    s_add_u32 s4, s46, 0
    s_addc_u32 s5, s47, 0
    s_mov_b32 exec_hi, 0x00ffffff
    buffer_load_dwordx4 v[10:13], v3, s[48:51], s77 offen nt
    s_mov_b32 exec_hi, -1
    buffer_load_dwordx2 v[8:9], v4, s[4:7], 0 offen sc1
    s_mov_b64 s[52:53], s[36:37]
    s_mov_b64 s[56:57], s[38:39]
    s_mov_b64 s[60:61], s[40:41]
    s_mov_b64 s[64:65], s[42:43]
    s_lshl_b32 s0, s8, 5
    s_add_u32 s0, s0, s9
    s_barrier
    s_cmp_ge_u32 s9, 28
    s_cbranch_scc1 Lhelp_pre
    global_load_ushort v16, v14, s[18:19] nt
    global_load_ushort v17, v14, s[20:21] nt
    global_load_ushort v18, v14, s[22:23] nt
    global_load_ushort v19, v14, s[24:25] nt
    global_load_ushort v20, v14, s[26:27] nt
    global_load_ushort v21, v14, s[28:29] nt
    s_lshl_b32 s72, s15, 2
    s_load_dword s74, s[30:31], s72
    s_load_dword s75, s[32:33], s72
    s_lshl_b32 s34, s11, 3
    v_mul_u32_u24 v5, 3584, v5
    v_add_u32 v5, v5, v6
    s_cmp_eq_u32 s3, 7
    s_cbranch_scc1 Lw1
    s_sub_u32 s71, s73, s34
    s_cselect_b32 s72, 56, 0
    s_add_u32 s71, s71, s72
    s_lshl_b32 s71, s71, 10
    s_add_u32 m0, s71, 34816
    s_mul_i32 s72, s73, 28672
    s_add_u32 s72, s72, s76
    buffer_load_dwordx4 v5, s[52:55], s72 offen  lds
    s_add_u32 m0, s71, 92160
    s_add_u32 s73, s73, 1
    buffer_load_dwordx4 v5, s[56:59], s72 offen  lds
Lw1:
    s_cmp_eq_u32 s3, 7
    s_cbranch_scc1 Lw2
    s_sub_u32 s71, s73, s34
    s_cselect_b32 s72, 56, 0
    s_add_u32 s71, s71, s72
    s_lshl_b32 s71, s71, 10
    s_add_u32 m0, s71, 34816
    s_mul_i32 s72, s73, 28672
    s_add_u32 s72, s72, s76
    buffer_load_dwordx4 v5, s[52:55], s72 offen  lds
    s_add_u32 m0, s71, 92160
    s_add_u32 s73, s73, 13
    buffer_load_dwordx4 v5, s[56:59], s72 offen  lds
    s_cmp_ge_u32 s73, 56
    s_cselect_b32 s71, 56, 0
    s_sub_u32 s73, s73, s71
Lw2:
    s_cmp_eq_u32 s3, 7
    s_cbranch_scc1 Lw3
    s_sub_u32 s71, s73, s34
    s_cselect_b32 s72, 56, 0
    s_add_u32 s71, s71, s72
    s_lshl_b32 s71, s71, 10
    s_add_u32 m0, s71, 34816
    s_mul_i32 s72, s73, 28672
    s_add_u32 s72, s72, s76
    buffer_load_dwordx4 v5, s[52:55], s72 offen  lds
    s_add_u32 m0, s71, 92160
    s_add_u32 s73, s73, 1
    buffer_load_dwordx4 v5, s[56:59], s72 offen  lds
Lw3:
    v_lshrrev_b32 v7, 5, v1
    v_lshlrev_b32 v7, 3, v7
    v_bfe_u32 v15, v1, 2, 2
    v_add_u32 v7, v7, v15
    v_lshlrev_b32 v7, 7, v7
    v_bfe_u32 v15, v1, 3, 1
    v_lshl_add_u32 v7, v15, 6, v7
    v_bfe_u32 v15, v1, 4, 1
    v_lshl_add_u32 v7, v15, 5, v7
    v_and_b32_e64 v15, 3, v1
    v_lshl_add_u32 v7, v15, 3, v7
    v_add_u32 v7, 34816, v7
    v_lshlrev_b32 v6, 5, v15
    s_mul_i32 s71, s3, 4352
    s_mov_b32 s35, s71
    v_and_b32 v63, 15, v1
    v_mul_u32_u24 v61, 272, v63
    v_lshrrev_b32 v62, 4, v1
    v_lshl_add_u32 v61, v62, 4, v61
    v_add_u32 v61, s71, v61
    v_lshlrev_b32 v63, 4, v63
    v_lshl_add_u32 v63, v62, 9, v63
    v_add_u32 v63, s71, v63
    s_cmp_lg_u32 s3, 7
    s_cbranch_scc1 Lw10
    s_waitcnt vmcnt(6)
    s_branch Lln
Lw10:
    s_waitcnt vmcnt(12)
    s_branch Lln
Lhelp_pre:
    s_sub_u32 s71, s9, 28
    s_lshl_b32 s71, s71, 3
    s_add_u32 s71, s71, s8
    s_lshl_b32 s76, s3, 5
    s_add_u32 s71, s71, s76
    v_mul_u32_u24 v5, 896, v5
    v_add_u32 v5, v5, v6
    s_mul_i32 s72, s71, 9363
    s_lshr_b32 s72, s72, 16
    s_mul_i32 s73, s72, 7
    s_sub_u32 s73, s71, s73
    s_mul_i32 s74, s72, 57344
    s_lshl_b32 s75, s73, 7
    s_add_u32 s74, s74, s75
    s_lshl_b32 s75, s3, 13
    s_cmp_gt_u32 s71, 195
    s_cbranch_scc1 Lhelp_none
    s_mov_b32 m0, s75
    s_add_u32 s75, s75, 1024
    buffer_load_dwordx4 v5, s[60:63], s74 offen nt lds
    s_add_u32 s74, s74, 7168
    s_mov_b32 m0, s75
    s_add_u32 s75, s75, 1024
    buffer_load_dwordx4 v5, s[60:63], s74 offen nt lds
    s_add_u32 s74, s74, 7168
    s_waitcnt vmcnt(2)
    s_branch Lln
Lhelp_none:
    s_waitcnt vmcnt(0)
    s_cmp_eq_u32 s3, 7
    s_cbranch_scc1 Lln
    s_waitcnt vmcnt(0)
Lln:
    v_readfirstlane_b32 s68, v8
    v_readfirstlane_b32 s69, v9
    v_lshlrev_b32 v24, 16, v10
    v_and_b32 v25, 0xffff0000, v10
    v_lshlrev_b32 v26, 16, v11
    v_and_b32 v27, 0xffff0000, v11
    v_lshlrev_b32 v28, 16, v12
    v_and_b32 v29, 0xffff0000, v12
    v_lshlrev_b32 v30, 16, v13
    v_and_b32 v31, 0xffff0000, v13
    s_add_u32 s68, s68, 0x7f4a7c15
    s_addc_u32 s69, s69, 0x9e3779b9
    v_add_f32 v32, v24, v25
    v_add_f32 v33, v26, v27
    v_add_f32 v34, v28, v29
    v_add_f32 v35, v30, v31
    v_add_f32 v32, v32, v33
    v_add_f32 v34, v34, v35
    v_add_f32 v32, v32, v34
    s_nop 1
    v_add_f32_dpp v32, v32, v32 row_shr:1 row_mask:0xf bank_mask:0xf bound_ctrl:0
    s_nop 1
    v_add_f32_dpp v32, v32, v32 row_shr:2 row_mask:0xf bank_mask:0xf bound_ctrl:0
    s_nop 1
    v_add_f32_dpp v32, v32, v32 row_shr:4 row_mask:0xf bank_mask:0xf bound_ctrl:0
    s_nop 1
    v_add_f32_dpp v32, v32, v32 row_shr:8 row_mask:0xf bank_mask:0xf bound_ctrl:0
    s_nop 1
    v_add_f32_dpp v32, v32, v32 row_bcast:15 row_mask:0xa bank_mask:0xf
    s_nop 1
    v_add_f32_dpp v32, v32, v32 row_bcast:31 row_mask:0xc bank_mask:0xf
    s_nop 0
    v_readlane_b32 s70, v32, 63
    v_mov_b32 v33, 0x3b124925
    s_nop 0
    v_mul_f32 v33, s70, v33
    v_mov_b32 v32, 0
    s_mov_b32 exec_hi, 0x00ffffff
    v_sub_f32 v34, v24, v33
    v_sub_f32 v35, v25, v33
    v_sub_f32 v36, v26, v33
    v_sub_f32 v37, v27, v33
    v_sub_f32 v38, v28, v33
    v_sub_f32 v39, v29, v33
    v_sub_f32 v40, v30, v33
    v_sub_f32 v41, v31, v33
    v_fmac_f32 v32, v34, v34
    v_fmac_f32 v32, v35, v35
    v_fmac_f32 v32, v36, v36
    v_fmac_f32 v32, v37, v37
    v_fmac_f32 v32, v38, v38
    v_fmac_f32 v32, v39, v39
    v_fmac_f32 v32, v40, v40
    v_fmac_f32 v32, v41, v41
    s_mov_b32 exec_hi, -1
    s_nop 0
    v_add_f32_dpp v32, v32, v32 row_shr:1 row_mask:0xf bank_mask:0xf bound_ctrl:0
    s_nop 1
    v_add_f32_dpp v32, v32, v32 row_shr:2 row_mask:0xf bank_mask:0xf bound_ctrl:0
    s_nop 1
    v_add_f32_dpp v32, v32, v32 row_shr:4 row_mask:0xf bank_mask:0xf bound_ctrl:0
    s_nop 1
    v_add_f32_dpp v32, v32, v32 row_shr:8 row_mask:0xf bank_mask:0xf bound_ctrl:0
    s_nop 1
    v_add_f32_dpp v32, v32, v32 row_bcast:15 row_mask:0xa bank_mask:0xf
    s_nop 1
    v_add_f32_dpp v32, v32, v32 row_bcast:31 row_mask:0xc bank_mask:0xf
    s_nop 0
    v_readlane_b32 s70, v32, 63
    v_mov_b32 v34, 0x3b124925
    s_nop 0
    v_mul_f32 v34, s70, v34
    v_cvt_pk_bf16_f32 v35, v33, v34
    v_lshlrev_b32 v33, 16, v35
    v_and_b32 v34, 0xffff0000, v35
    v_add_f32 v34, 0x3727c5ac, v34
    v_cvt_pk_bf16_f32 v34, v34, v34
    v_lshlrev_b32 v34, 16, v34
    v_sqrt_f32 v34, v34
    s_nop 0
    v_cvt_pk_bf16_f32 v34, v34, v34
    v_lshlrev_b32 v34, 16, v34
    v_rcp_f32 v34, v34
    v_sub_f32 v24, v24, v33
    v_sub_f32 v25, v25, v33
    v_sub_f32 v26, v26, v33
    v_sub_f32 v27, v27, v33
    v_sub_f32 v28, v28, v33
    v_sub_f32 v29, v29, v33
    v_sub_f32 v30, v30, v33
    v_sub_f32_e64 v31, v31, v33
    v_cvt_pk_bf16_f32 v10, v24, v25
    v_cvt_pk_bf16_f32 v11, v26, v27
    v_cvt_pk_bf16_f32 v12, v28, v29
    v_cvt_pk_bf16_f32 v13, v30, v31
    v_lshlrev_b32 v24, 16, v10
    v_and_b32 v25, 0xffff0000, v10
    v_lshlrev_b32 v26, 16, v11
    v_and_b32 v27, 0xffff0000, v11
    v_lshlrev_b32 v28, 16, v12
    v_and_b32 v29, 0xffff0000, v12
    v_lshlrev_b32 v30, 16, v13
    v_and_b32 v31, 0xffff0000, v13
    v_mul_f32 v24, v24, v34
    v_mul_f32 v25, v25, v34
    v_mul_f32 v26, v26, v34
    v_mul_f32 v27, v27, v34
    v_mul_f32 v28, v28, v34
    v_mul_f32 v29, v29, v34
    v_mul_f32 v30, v30, v34
    v_mul_f32 v31, v31, v34
    v_cvt_pk_bf16_f32 v10, v24, v25
    v_cvt_pk_bf16_f32 v11, v26, v27
    v_cvt_pk_bf16_f32 v12, v28, v29
    v_cvt_pk_bf16_f32 v13, v30, v31
    v_mul_u32_u24 v32, 144, v1
    s_lshl_b32 s70, s3, 4
    s_add_u32 s70, s70, 149504
    v_add_u32 v32, s70, v32
    s_mov_b32 exec_hi, 0x00ffffff
    ds_write_b128 v32, v[10:13]
    s_mov_b32 exec_hi, -1
    v_lshrrev_b32 v32, 3, v1
    v_and_b32 v33, 7, v1
    v_lshlrev_b32 v33, 4, v33
    v_mul_u32_u24 v34, 144, v32
    v_add_u32_e64 v34, v34, v33
    v_add_u32 v34, 149504, v34
    v_lshl_add_u32 v35, v32, 9, v33
    s_lshr_b32 s70, s0, 2
    s_mul_i32 s70, s70, 28672
    s_and_b32 s77, s0, 3
    s_lshl_b32 s77, s77, 7
    s_add_u32 s70, s70, s77
    s_add_u32 s70, s70, 262144
    s_waitcnt lgkmcnt(0)
    s_barrier
    s_cmp_lg_u32 s3, 7
    s_cbranch_scc1 Lln_done
    ds_read_b128 v[144:147], v34 offset:0
    ds_read_b128 v[148:151], v34 offset:1152
    ds_read_b128 v[152:155], v34 offset:2304
    ds_read_b128 v[156:159], v34 offset:3456
    ds_read_b128 v[160:163], v34 offset:4608
    ds_read_b128 v[164:167], v34 offset:5760
    ds_read_b128 v[168:171], v34 offset:6912
    s_waitcnt lgkmcnt(6)
    buffer_store_dwordx4 v[144:147], v35, s[4:7], s70 offen sc1
    s_add_u32 s70, s70, 4096
    s_waitcnt lgkmcnt(5)
    buffer_store_dwordx4 v[148:151], v35, s[4:7], s70 offen sc1
    s_add_u32 s70, s70, 4096
    s_waitcnt lgkmcnt(4)
    buffer_store_dwordx4 v[152:155], v35, s[4:7], s70 offen sc1
    s_add_u32 s70, s70, 4096
    s_waitcnt lgkmcnt(3)
    buffer_store_dwordx4 v[156:159], v35, s[4:7], s70 offen sc1
    s_add_u32 s70, s70, 4096
    s_waitcnt lgkmcnt(2)
    buffer_store_dwordx4 v[160:163], v35, s[4:7], s70 offen sc1
    s_add_u32 s70, s70, 4096
    s_waitcnt lgkmcnt(1)
    buffer_store_dwordx4 v[164:167], v35, s[4:7], s70 offen sc1
    s_add_u32 s70, s70, 4096
    s_waitcnt lgkmcnt(0)
    buffer_store_dwordx4 v[168:171], v35, s[4:7], s70 offen sc1
    s_add_u32 s70, s70, 4096
    s_waitcnt vmcnt(7)
    s_branch Lln_d2
Lln_done:
    s_waitcnt vmcnt(6)
Lln_d2:
    s_cmp_ge_u32 s9, 28
    s_cbranch_scc1 Lhelper
    s_mov_b32 m0, s35
    s_cmp_lt_u32 s3, 4
    s_cbranch_scc1 Lnoyp
    s_setprio 1
Lnoyp:
    v_lshlrev_b32 v16, 16, v16
    v_lshlrev_b32 v17, 16, v17
    v_lshlrev_b32 v18, 16, v18
    v_lshlrev_b32 v19, 16, v19
    v_lshlrev_b32 v20, 16, v20
    v_lshlrev_b32 v21, 16, v21
    s_cmp_ge_u32 s3, 4
    s_cselect_b32 s71, 0, 16
    s_lshl_b32 s72, s74, s71
    s_and_b32 s72, s72, 0xffff0000
    v_mov_b32 v22, 0x3fb8aa3b
    v_mul_f32 v23, s72, v22
    v_exp_f32 v23, v23
    s_nop 0
    v_cvt_pk_bf16_f32 v23, v23, v23
    v_lshlrev_b32 v23, 16, v23
    v_mul_f32 v16, v23, v16
    v_mul_f32 v17, v23, v17
    v_mul_f32 v18, v23, v18
    v_mul_f32 v19, v23, v19
    v_mul_f32 v16, v22, v16
    v_mul_f32 v17, 0.15915494, v17
    v_mul_f32 v38, 1.0, v16
    v_mul_f32 v39, 1.0, v17
    v_exp_f32 v38, v38
    v_fract_f32 v39, v39
    v_cos_f32 v24, v39
    v_sin_f32 v25, v39
    v_mul_f32 v24, v38, v24
    v_mul_f32_e64 v25, v38, v25
    v_mul_f32 v38, 8.0, v16
    v_mul_f32 v39, 8.0, v17
    v_exp_f32 v38, v38
    v_fract_f32 v39, v39
    v_cos_f32 v26, v39
    v_sin_f32 v27, v39
    v_mul_f32 v26, v38, v26
    v_mul_f32 v27, v38, v27
    v_mul_f32 v38, 256.0, v16
    v_mul_f32 v39, 256.0, v17
    v_exp_f32 v38, v38
    v_fract_f32 v39, v39
    v_cos_f32 v28, v39
    v_sin_f32 v29, v39
    v_mul_f32 v28, v38, v28
    v_mul_f32 v29, v38, v29
    v_pk_mul_f32 v[36:37], v[20:21], v[18:19] op_sel:[0,0] op_sel_hi:[1,0]
    v_pk_fma_f32 v[34:35], v[20:21], v[18:19], v[36:37] op_sel:[1,1,0] op_sel_hi:[0,1,1] neg_lo:[1,0,0]
    v_pk_mul_f32 v[36:37], v[24:25], v[24:25] op_sel:[0,0] op_sel_hi:[1,0]
    v_pk_fma_f32 v[30:31], v[24:25], v[24:25], v[36:37] op_sel:[1,1,0] op_sel_hi:[0,1,1] neg_lo:[1,0,0]
    v_pk_mul_f32 v[36:37], v[30:31], v[30:31] op_sel:[0,0] op_sel_hi:[1,0]
    v_pk_fma_f32 v[32:33], v[30:31], v[30:31], v[36:37] op_sel:[1,1,0] op_sel_hi:[0,1,1] neg_lo:[1,0,0]
    s_cmp_eq_u32 s3, 7
    s_cbranch_scc1 Lw4
    s_sub_u32 s71, s73, s34
    s_cselect_b32 s72, 56, 0
    s_add_u32 s71, s71, s72
    s_lshl_b32 s71, s71, 10
    s_add_u32 m0, s71, 34816
    s_mul_i32 s72, s73, 28672
    s_add_u32 s72, s72, s76
    buffer_load_dwordx4 v5, s[52:55], s72 offen  lds
    s_add_u32 m0, s71, 92160
    s_add_u32 s73, s73, 13
    buffer_load_dwordx4 v5, s[56:59], s72 offen  lds
    s_cmp_ge_u32 s73, 56
    s_cselect_b32 s71, 56, 0
    s_sub_u32 s73, s73, s71
    s_mov_b32 m0, s35
Lw4:
    v_cvt_pk_bf16_f32 v44, v34, -v35
    ds_write_addtid_b32 v44 offset:0
    v_pk_mul_f32 v[36:37], v[34:35], v[24:25] op_sel:[0,0] op_sel_hi:[1,0]
    v_pk_fma_f32 v[48:49], v[34:35], v[24:25], v[36:37] op_sel:[1,1,0] op_sel_hi:[0,1,1] neg_lo:[1,0,0]
    v_cvt_pk_bf16_f32 v45, v48, -v49
    ds_write_addtid_b32 v45 offset:272
    v_pk_mul_f32 v[36:37], v[48:49], v[24:25] op_sel:[0,0] op_sel_hi:[1,0]
    v_pk_fma_f32 v[50:51], v[48:49], v[24:25], v[36:37] op_sel:[1,1,0] op_sel_hi:[0,1,1] neg_lo:[1,0,0]
    v_cvt_pk_bf16_f32 v46, v50, -v51
    ds_write_addtid_b32 v46 offset:544
    v_pk_mul_f32 v[36:37], v[50:51], v[24:25] op_sel:[0,0] op_sel_hi:[1,0]
    v_pk_fma_f32 v[48:49], v[50:51], v[24:25], v[36:37] op_sel:[1,1,0] op_sel_hi:[0,1,1] neg_lo:[1,0,0]
    v_cvt_pk_bf16_f32 v47, v48, -v49
    ds_write_addtid_b32 v47 offset:816
    v_pk_mul_f32 v[36:37], v[48:49], v[24:25] op_sel:[0,0] op_sel_hi:[1,0]
    v_pk_fma_f32 v[50:51], v[48:49], v[24:25], v[36:37] op_sel:[1,1,0] op_sel_hi:[0,1,1] neg_lo:[1,0,0]
    v_cvt_pk_bf16_f32 v44, v50, -v51
    ds_write_addtid_b32 v44 offset:1088
    v_pk_mul_f32 v[36:37], v[50:51], v[24:25] op_sel:[0,0] op_sel_hi:[1,0]
    v_pk_fma_f32 v[48:49], v[50:51], v[24:25], v[36:37] op_sel:[1,1,0] op_sel_hi:[0,1,1] neg_lo:[1,0,0]
    v_cvt_pk_bf16_f32 v45, v48, -v49
    ds_write_addtid_b32 v45 offset:1360
    v_pk_mul_f32 v[36:37], v[48:49], v[24:25] op_sel:[0,0] op_sel_hi:[1,0]
    v_pk_fma_f32 v[50:51], v[48:49], v[24:25], v[36:37] op_sel:[1,1,0] op_sel_hi:[0,1,1] neg_lo:[1,0,0]
    v_cvt_pk_bf16_f32 v46, v50, -v51
    ds_write_addtid_b32 v46 offset:1632
    v_pk_mul_f32 v[36:37], v[50:51], v[24:25] op_sel:[0,0] op_sel_hi:[1,0]
    v_pk_fma_f32 v[48:49], v[50:51], v[24:25], v[36:37] op_sel:[1,1,0] op_sel_hi:[0,1,1] neg_lo:[1,0,0]
    v_cvt_pk_bf16_f32 v47, v48, -v49
    ds_write_addtid_b32 v47 offset:1904
    s_cmp_eq_u32 s3, 7
    s_cbranch_scc1 Lw5
    s_sub_u32 s71, s73, s34
    s_cselect_b32 s72, 56, 0
    s_add_u32 s71, s71, s72
    s_lshl_b32 s71, s71, 10
    s_add_u32 m0, s71, 34816
    s_mul_i32 s72, s73, 28672
    s_add_u32 s72, s72, s76
    buffer_load_dwordx4 v5, s[52:55], s72 offen  lds
    s_add_u32 m0, s71, 92160
    s_add_u32 s73, s73, 1
    buffer_load_dwordx4 v5, s[56:59], s72 offen  lds
    s_mov_b32 m0, s35
Lw5:
    s_nop 0
    v_pk_mul_f32 v[36:37], v[34:35], v[28:29] op_sel:[0,0] op_sel_hi:[1,0]
    v_pk_fma_f32 v[52:53], v[34:35], v[28:29], v[36:37] op_sel:[1,1,0] op_sel_hi:[0,1,1] neg_lo:[1,0,0]
    v_cvt_pk_bf16_f32 v44, v52, -v53
    ds_write_addtid_b32 v44 offset:2176
    v_pk_mul_f32 v[36:37], v[52:53], v[30:31] op_sel:[0,0] op_sel_hi:[1,0]
    v_pk_fma_f32 v[48:49], v[52:53], v[30:31], v[36:37] op_sel:[1,1,0] op_sel_hi:[0,1,1] neg_lo:[1,0,0]
    v_cvt_pk_bf16_f32 v45, v48, -v49
    ds_write_addtid_b32 v45 offset:2448
    v_pk_mul_f32 v[36:37], v[48:49], v[30:31] op_sel:[0,0] op_sel_hi:[1,0]
    v_pk_fma_f32 v[50:51], v[48:49], v[30:31], v[36:37] op_sel:[1,1,0] op_sel_hi:[0,1,1] neg_lo:[1,0,0]
    v_cvt_pk_bf16_f32 v46, v50, -v51
    ds_write_addtid_b32 v46 offset:2720
    v_pk_mul_f32 v[36:37], v[50:51], v[30:31] op_sel:[0,0] op_sel_hi:[1,0]
    v_pk_fma_f32 v[48:49], v[50:51], v[30:31], v[36:37] op_sel:[1,1,0] op_sel_hi:[0,1,1] neg_lo:[1,0,0]
    v_cvt_pk_bf16_f32 v47, v48, -v49
    ds_write_addtid_b32 v47 offset:2992
    v_pk_mul_f32 v[36:37], v[52:53], v[28:29] op_sel:[0,0] op_sel_hi:[1,0]
    v_pk_fma_f32 v[34:35], v[52:53], v[28:29], v[36:37] op_sel:[1,1,0] op_sel_hi:[0,1,1] neg_lo:[1,0,0]
    v_cvt_pk_bf16_f32 v44, v34, -v35
    ds_write_addtid_b32 v44 offset:3264
    v_pk_mul_f32 v[36:37], v[34:35], v[32:33] op_sel:[0,0] op_sel_hi:[1,0]
    v_pk_fma_f32 v[48:49], v[34:35], v[32:33], v[36:37] op_sel:[1,1,0] op_sel_hi:[0,1,1] neg_lo:[1,0,0]
    v_cvt_pk_bf16_f32 v45, v48, -v49
    ds_write_addtid_b32 v45 offset:3536
    v_pk_mul_f32 v[36:37], v[34:35], v[28:29] op_sel:[0,0] op_sel_hi:[1,0]
    v_pk_fma_f32 v[52:53], v[34:35], v[28:29], v[36:37] op_sel:[1,1,0] op_sel_hi:[0,1,1] neg_lo:[1,0,0]
    v_cvt_pk_bf16_f32 v46, v52, -v53
    ds_write_addtid_b32 v46 offset:3808
    v_pk_mul_f32 v[36:37], v[52:53], v[32:33] op_sel:[0,0] op_sel_hi:[1,0]
    v_pk_fma_f32 v[48:49], v[52:53], v[32:33], v[36:37] op_sel:[1,1,0] op_sel_hi:[0,1,1] neg_lo:[1,0,0]
    v_cvt_pk_bf16_f32 v47, v48, -v49
    ds_write_addtid_b32 v47 offset:4080
    ds_read_b128 v[64:67], v61 offset:0
    ds_read_b128 v[68:71], v61 offset:64
    ds_read_b128 v[72:75], v61 offset:128
    ds_read_b128 v[76:79], v61 offset:192
    s_cmp_eq_u32 s3, 7
    s_cbranch_scc1 Lw6
    s_sub_u32 s71, s73, s34
    s_cselect_b32 s72, 56, 0
    s_add_u32 s71, s71, s72
    s_lshl_b32 s71, s71, 10
    s_add_u32 m0, s71, 34816
    s_mul_i32 s72, s73, 28672
    s_add_u32 s72, s72, s76
    buffer_load_dwordx4 v5, s[52:55], s72 offen  lds
    s_add_u32 m0, s71, 92160
    s_add_u32 s73, s73, 13
    buffer_load_dwordx4 v5, s[56:59], s72 offen  lds
    s_cmp_ge_u32 s73, 56
    s_cselect_b32 s71, 56, 0
    s_sub_u32 s73, s73, s71
    s_mov_b32 m0, s35
Lw6:
    s_cmp_lg_u32 s3, 7
    s_cbranch_scc1 Lf7
    s_lshl_b32 s70, s0, 5
    s_add_u32 s70, s70, 4096
    s_waitcnt vmcnt(0)
    v_mov_b32 v14, s68
    v_mov_b32 v15, s69
    s_mov_b64 exec, 1
    buffer_store_dwordx2 v[14:15], off, s[4:7], s70 sc1
    s_mov_b64 exec, -1
Lf7:
    v_pk_mul_f32 v[36:37], v[52:53], v[28:29] op_sel:[0,0] op_sel_hi:[1,0]
    v_pk_fma_f32 v[48:49], v[52:53], v[28:29], v[36:37] op_sel:[1,1,0] op_sel_hi:[0,1,1] neg_lo:[1,0,0]
    v_cvt_pk_bf16_f32 v44, v48, -v49
    ds_write_addtid_b32 v44 offset:0
    v_pk_mul_f32 v[36:37], v[48:49], v[28:29] op_sel:[0,0] op_sel_hi:[1,0]
    v_pk_fma_f32 v[50:51], v[48:49], v[28:29], v[36:37] op_sel:[1,1,0] op_sel_hi:[0,1,1] neg_lo:[1,0,0]
    v_cvt_pk_bf16_f32 v45, v50, -v51
    ds_write_addtid_b32 v45 offset:272
    v_pk_mul_f32 v[36:37], v[50:51], v[28:29] op_sel:[0,0] op_sel_hi:[1,0]
    v_pk_fma_f32 v[48:49], v[50:51], v[28:29], v[36:37] op_sel:[1,1,0] op_sel_hi:[0,1,1] neg_lo:[1,0,0]
    v_cvt_pk_bf16_f32 v46, v48, -v49
    ds_write_addtid_b32 v46 offset:544
    v_pk_mul_f32 v[36:37], v[48:49], v[28:29] op_sel:[0,0] op_sel_hi:[1,0]
    v_pk_fma_f32 v[50:51], v[48:49], v[28:29], v[36:37] op_sel:[1,1,0] op_sel_hi:[0,1,1] neg_lo:[1,0,0]
    v_cvt_pk_bf16_f32 v47, v50, -v51
    ds_write_addtid_b32 v47 offset:816
    v_pk_mul_f32 v[36:37], v[50:51], v[28:29] op_sel:[0,0] op_sel_hi:[1,0]
    v_pk_fma_f32 v[48:49], v[50:51], v[28:29], v[36:37] op_sel:[1,1,0] op_sel_hi:[0,1,1] neg_lo:[1,0,0]
    v_cvt_pk_bf16_f32 v44, v48, -v49
    ds_write_addtid_b32 v44 offset:1088
    ds_read_b128 v[80:83], v61 offset:0
    ds_read_b128 v[84:87], v61 offset:64
    ds_read_b128 v[88:91], v61 offset:128
    ds_read_b128 v[92:95], v61 offset:192
    s_cmp_eq_u32 s3, 7
    s_cbranch_scc1 Lw8
    s_sub_u32 s71, s73, s34
    s_cselect_b32 s72, 56, 0
    s_add_u32 s71, s71, s72
    s_lshl_b32 s71, s71, 10
    s_add_u32 m0, s71, 34816
    s_mul_i32 s72, s73, 28672
    s_add_u32 s72, s72, s76
    buffer_load_dwordx4 v5, s[52:55], s72 offen  lds
    s_add_u32 m0, s71, 92160
    s_add_u32 s73, s73, 1
    buffer_load_dwordx4 v5, s[56:59], s72 offen  lds
    s_mov_b32 m0, s35
Lw8:
    s_setprio 0
    v_mov_b32 v44, 0x3f80
    ds_write_addtid_b32 v44
    v_cvt_pk_bf16_f32 v45, v26, v27
    ds_write_addtid_b32 v45 offset:272
    v_pk_mul_f32 v[36:37], v[26:27], v[26:27] op_sel:[0,0] op_sel_hi:[1,0]
    v_pk_fma_f32 v[48:49], v[26:27], v[26:27], v[36:37] op_sel:[1,1,0] op_sel_hi:[0,1,1] neg_lo:[1,0,0]
    v_cvt_pk_bf16_f32 v46, v48, v49
    ds_write_addtid_b32 v46 offset:544
    v_pk_mul_f32 v[36:37], v[48:49], v[26:27] op_sel:[0,0] op_sel_hi:[1,0]
    v_pk_fma_f32 v[50:51], v[48:49], v[26:27], v[36:37] op_sel:[1,1,0] op_sel_hi:[0,1,1] neg_lo:[1,0,0]
    v_cvt_pk_bf16_f32 v47, v50, v51
    ds_write_addtid_b32 v47 offset:816
    v_pk_mul_f32 v[36:37], v[50:51], v[26:27] op_sel:[0,0] op_sel_hi:[1,0]
    v_pk_fma_f32 v[48:49], v[50:51], v[26:27], v[36:37] op_sel:[1,1,0] op_sel_hi:[0,1,1] neg_lo:[1,0,0]
    v_cvt_pk_bf16_f32 v44, v48, v49
    ds_write_addtid_b32 v44 offset:1088
    v_pk_mul_f32 v[36:37], v[48:49], v[26:27] op_sel:[0,0] op_sel_hi:[1,0]
    v_pk_fma_f32 v[50:51], v[48:49], v[26:27], v[36:37] op_sel:[1,1,0] op_sel_hi:[0,1,1] neg_lo:[1,0,0]
    v_cvt_pk_bf16_f32 v45, v50, v51
    ds_write_addtid_b32 v45 offset:1360
    v_pk_mul_f32 v[36:37], v[50:51], v[26:27] op_sel:[0,0] op_sel_hi:[1,0]
    v_pk_fma_f32 v[48:49], v[50:51], v[26:27], v[36:37] op_sel:[1,1,0] op_sel_hi:[0,1,1] neg_lo:[1,0,0]
    v_cvt_pk_bf16_f32 v46, v48, v49
    ds_write_addtid_b32 v46 offset:1632
    v_pk_mul_f32 v[36:37], v[48:49], v[26:27] op_sel:[0,0] op_sel_hi:[1,0]
    v_pk_fma_f32 v[50:51], v[48:49], v[26:27], v[36:37] op_sel:[1,1,0] op_sel_hi:[0,1,1] neg_lo:[1,0,0]
    v_cvt_pk_bf16_f32 v47, v50, v51
    ds_write_addtid_b32 v47 offset:1904
    v_pk_mul_f32 v[36:37], v[50:51], v[26:27] op_sel:[0,0] op_sel_hi:[1,0]
    v_pk_fma_f32 v[48:49], v[50:51], v[26:27], v[36:37] op_sel:[1,1,0] op_sel_hi:[0,1,1] neg_lo:[1,0,0]
    v_cvt_pk_bf16_f32 v44, v48, v49
    ds_write_addtid_b32 v44 offset:2176
    s_cmp_eq_u32 s3, 7
    s_cbranch_scc1 Lw9
    s_sub_u32 s71, s73, s34
    s_cselect_b32 s72, 56, 0
    s_add_u32 s71, s71, s72
    s_lshl_b32 s71, s71, 10
    s_add_u32 m0, s71, 34816
    s_mul_i32 s72, s73, 28672
    s_add_u32 s72, s72, s76
    buffer_load_dwordx4 v5, s[52:55], s72 offen  lds
    s_add_u32 m0, s71, 92160
    s_add_u32 s73, s73, 13
    buffer_load_dwordx4 v5, s[56:59], s72 offen  lds
    s_cmp_ge_u32 s73, 56
    s_cselect_b32 s71, 56, 0
    s_sub_u32 s73, s73, s71
    s_mov_b32 m0, s35
Lw9:
    v_pk_mul_f32 v[36:37], v[48:49], v[26:27] op_sel:[0,0] op_sel_hi:[1,0]
    v_pk_fma_f32 v[50:51], v[48:49], v[26:27], v[36:37] op_sel:[1,1,0] op_sel_hi:[0,1,1] neg_lo:[1,0,0]
    v_cvt_pk_bf16_f32 v45, v50, v51
    ds_write_addtid_b32 v45 offset:2448
    v_pk_mul_f32 v[36:37], v[50:51], v[26:27] op_sel:[0,0] op_sel_hi:[1,0]
    v_pk_fma_f32 v[48:49], v[50:51], v[26:27], v[36:37] op_sel:[1,1,0] op_sel_hi:[0,1,1] neg_lo:[1,0,0]
    v_cvt_pk_bf16_f32 v46, v48, v49
    ds_write_addtid_b32 v46 offset:2720
    v_pk_mul_f32 v[36:37], v[48:49], v[26:27] op_sel:[0,0] op_sel_hi:[1,0]
    v_pk_fma_f32 v[50:51], v[48:49], v[26:27], v[36:37] op_sel:[1,1,0] op_sel_hi:[0,1,1] neg_lo:[1,0,0]
    v_cvt_pk_bf16_f32 v47, v50, v51
    ds_write_addtid_b32 v47 offset:2992
    v_pk_mul_f32 v[36:37], v[50:51], v[26:27] op_sel:[0,0] op_sel_hi:[1,0]
    v_pk_fma_f32 v[48:49], v[50:51], v[26:27], v[36:37] op_sel:[1,1,0] op_sel_hi:[0,1,1] neg_lo:[1,0,0]
    v_cvt_pk_bf16_f32 v44, v48, v49
    ds_write_addtid_b32 v44 offset:3264
    v_pk_mul_f32 v[36:37], v[48:49], v[26:27] op_sel:[0,0] op_sel_hi:[1,0]
    v_pk_fma_f32 v[50:51], v[48:49], v[26:27], v[36:37] op_sel:[1,1,0] op_sel_hi:[0,1,1] neg_lo:[1,0,0]
    v_cvt_pk_bf16_f32 v45, v50, v51
    ds_write_addtid_b32 v45 offset:3536
    v_pk_mul_f32 v[36:37], v[50:51], v[26:27] op_sel:[0,0] op_sel_hi:[1,0]
    v_pk_fma_f32 v[48:49], v[50:51], v[26:27], v[36:37] op_sel:[1,1,0] op_sel_hi:[0,1,1] neg_lo:[1,0,0]
    v_cvt_pk_bf16_f32 v46, v48, v49
    ds_write_addtid_b32 v46 offset:3808
    v_pk_mul_f32 v[36:37], v[48:49], v[26:27] op_sel:[0,0] op_sel_hi:[1,0]
    v_pk_fma_f32 v[50:51], v[48:49], v[26:27], v[36:37] op_sel:[1,1,0] op_sel_hi:[0,1,1] neg_lo:[1,0,0]
    v_cvt_pk_bf16_f32 v47, v50, v51
    ds_write_addtid_b32 v47 offset:4080
    ds_read_b128 v[96:99], v61 offset:0
    ds_read_b128 v[100:103], v61 offset:64
    ds_read_b128 v[104:107], v61 offset:128
    ds_read_b128 v[108:111], v61 offset:192
    v_pk_mul_f32 v[36:37], v[50:51], v[26:27] op_sel:[0,0] op_sel_hi:[1,0]
    v_pk_fma_f32 v[48:49], v[50:51], v[26:27], v[36:37] op_sel:[1,1,0] op_sel_hi:[0,1,1] neg_lo:[1,0,0]
    v_cvt_pk_bf16_f32 v44, v48, v49
    ds_write_addtid_b32 v44 offset:0
    v_pk_mul_f32 v[36:37], v[48:49], v[26:27] op_sel:[0,0] op_sel_hi:[1,0]
    v_pk_fma_f32 v[50:51], v[48:49], v[26:27], v[36:37] op_sel:[1,1,0] op_sel_hi:[0,1,1] neg_lo:[1,0,0]
    v_cvt_pk_bf16_f32 v45, v50, v51
    ds_write_addtid_b32 v45 offset:272
    v_pk_mul_f32 v[36:37], v[50:51], v[26:27] op_sel:[0,0] op_sel_hi:[1,0]
    v_pk_fma_f32 v[48:49], v[50:51], v[26:27], v[36:37] op_sel:[1,1,0] op_sel_hi:[0,1,1] neg_lo:[1,0,0]
    v_cvt_pk_bf16_f32 v46, v48, v49
    ds_write_addtid_b32 v46 offset:544
    v_pk_mul_f32 v[36:37], v[48:49], v[26:27] op_sel:[0,0] op_sel_hi:[1,0]
    v_pk_fma_f32 v[50:51], v[48:49], v[26:27], v[36:37] op_sel:[1,1,0] op_sel_hi:[0,1,1] neg_lo:[1,0,0]
    v_cvt_pk_bf16_f32 v47, v50, v51
    ds_write_addtid_b32 v47 offset:816
    v_pk_mul_f32 v[36:37], v[50:51], v[26:27] op_sel:[0,0] op_sel_hi:[1,0]
    v_pk_fma_f32 v[48:49], v[50:51], v[26:27], v[36:37] op_sel:[1,1,0] op_sel_hi:[0,1,1] neg_lo:[1,0,0]
    v_cvt_pk_bf16_f32 v44, v48, v49
    ds_write_addtid_b32 v44 offset:1088
    v_pk_mul_f32 v[36:37], v[48:49], v[26:27] op_sel:[0,0] op_sel_hi:[1,0]
    v_pk_fma_f32 v[50:51], v[48:49], v[26:27], v[36:37] op_sel:[1,1,0] op_sel_hi:[0,1,1] neg_lo:[1,0,0]
    v_cvt_pk_bf16_f32 v45, v50, v51
    ds_write_addtid_b32 v45 offset:1360
    v_pk_mul_f32 v[36:37], v[50:51], v[26:27] op_sel:[0,0] op_sel_hi:[1,0]
    v_pk_fma_f32 v[48:49], v[50:51], v[26:27], v[36:37] op_sel:[1,1,0] op_sel_hi:[0,1,1] neg_lo:[1,0,0]
    v_cvt_pk_bf16_f32 v46, v48, v49
    ds_write_addtid_b32 v46 offset:1632
    v_pk_mul_f32 v[36:37], v[48:49], v[26:27] op_sel:[0,0] op_sel_hi:[1,0]
    v_pk_fma_f32 v[50:51], v[48:49], v[26:27], v[36:37] op_sel:[1,1,0] op_sel_hi:[0,1,1] neg_lo:[1,0,0]
    v_cvt_pk_bf16_f32 v47, v50, v51
    ds_write_addtid_b32 v47 offset:1904
    v_pk_mul_f32 v[36:37], v[50:51], v[26:27] op_sel:[0,0] op_sel_hi:[1,0]
    v_pk_fma_f32 v[48:49], v[50:51], v[26:27], v[36:37] op_sel:[1,1,0] op_sel_hi:[0,1,1] neg_lo:[1,0,0]
    v_cvt_pk_bf16_f32 v44, v48, v49
    ds_write_addtid_b32 v44 offset:2176
    v_pk_mul_f32 v[36:37], v[48:49], v[26:27] op_sel:[0,0] op_sel_hi:[1,0]
    v_pk_fma_f32 v[50:51], v[48:49], v[26:27], v[36:37] op_sel:[1,1,0] op_sel_hi:[0,1,1] neg_lo:[1,0,0]
    v_cvt_pk_bf16_f32 v45, v50, v51
    ds_write_addtid_b32 v45 offset:2448
    v_pk_mul_f32 v[36:37], v[50:51], v[26:27] op_sel:[0,0] op_sel_hi:[1,0]
    v_pk_fma_f32 v[48:49], v[50:51], v[26:27], v[36:37] op_sel:[1,1,0] op_sel_hi:[0,1,1] neg_lo:[1,0,0]
    v_cvt_pk_bf16_f32 v46, v48, v49
    ds_write_addtid_b32 v46 offset:2720
    v_pk_mul_f32 v[36:37], v[48:49], v[26:27] op_sel:[0,0] op_sel_hi:[1,0]
    v_pk_fma_f32 v[50:51], v[48:49], v[26:27], v[36:37] op_sel:[1,1,0] op_sel_hi:[0,1,1] neg_lo:[1,0,0]
    v_cvt_pk_bf16_f32 v47, v50, v51
    ds_write_addtid_b32 v47 offset:2992
    v_pk_mul_f32 v[36:37], v[50:51], v[26:27] op_sel:[0,0] op_sel_hi:[1,0]
    v_pk_fma_f32 v[48:49], v[50:51], v[26:27], v[36:37] op_sel:[1,1,0] op_sel_hi:[0,1,1] neg_lo:[1,0,0]
    v_cvt_pk_bf16_f32 v44, v48, v49
    ds_write_addtid_b32 v44 offset:3264
    v_pk_mul_f32 v[36:37], v[48:49], v[26:27] op_sel:[0,0] op_sel_hi:[1,0]
    v_pk_fma_f32 v[50:51], v[48:49], v[26:27], v[36:37] op_sel:[1,1,0] op_sel_hi:[0,1,1] neg_lo:[1,0,0]
    v_cvt_pk_bf16_f32 v45, v50, v51
    ds_write_addtid_b32 v45 offset:3536
    v_pk_mul_f32 v[36:37], v[50:51], v[26:27] op_sel:[0,0] op_sel_hi:[1,0]
    v_pk_fma_f32 v[48:49], v[50:51], v[26:27], v[36:37] op_sel:[1,1,0] op_sel_hi:[0,1,1] neg_lo:[1,0,0]
    v_cvt_pk_bf16_f32 v46, v48, v49
    ds_write_addtid_b32 v46 offset:3808
    v_pk_mul_f32 v[36:37], v[48:49], v[26:27] op_sel:[0,0] op_sel_hi:[1,0]
    v_pk_fma_f32 v[50:51], v[48:49], v[26:27], v[36:37] op_sel:[1,1,0] op_sel_hi:[0,1,1] neg_lo:[1,0,0]
    v_cvt_pk_bf16_f32 v47, v50, v51
    ds_write_addtid_b32 v47 offset:4080
    ds_read_b128 v[112:115], v61 offset:0
    ds_read_b128 v[116:119], v61 offset:64
    ds_read_b128 v[120:123], v61 offset:128
    ds_read_b128 v[124:127], v61 offset:192
    s_lshl_b32 s70, s12, 2
    s_and_b32 s71, s3, 3
    s_add_u32 s70, s70, s71
    s_lshl_b32 s70, s70, 1
    s_lshr_b32 s71, s3, 2
    s_add_u32 s70, s70, s71
    s_lshl_b32 s71, s70, 7
    s_nop 0
    s_add_u32 s71, s71, 4096
    buffer_load_dwordx2 v[8:9], v6, s[4:7], s71 offen sc1
    s_mul_i32 s72, s70, 28672
    s_add_u32 s72, s72, 262144
    s_add_u32 s35, s72, 28672
    s_lshl_b32 s34, s11, 12
    s_add_u32 s72, s72, s34
    s_waitcnt lgkmcnt(4)
    s_nop 0
    v_mfma_f32_16x16x32_bf16 v[128:131], v[64:67], v[96:99], 0
    v_mfma_f32_16x16x32_bf16 v[128:131], v[68:71], v[100:103], v[128:131]
    v_mfma_f32_16x16x32_bf16 v[128:131], v[72:75], v[104:107], v[128:131]
    v_mfma_f32_16x16x32_bf16 v[128:131], v[76:79], v[108:111], v[128:131]
    v_mfma_f32_16x16x32_bf16 v[136:139], v[80:83], v[96:99], 0
    v_mfma_f32_16x16x32_bf16 v[136:139], v[84:87], v[100:103], v[136:139]
    v_mfma_f32_16x16x32_bf16 v[136:139], v[88:91], v[104:107], v[136:139]
    v_mfma_f32_16x16x32_bf16 v[136:139], v[92:95], v[108:111], v[136:139]
    s_waitcnt lgkmcnt(0)
    s_nop 0
    v_mfma_f32_16x16x32_bf16 v[132:135], v[64:67], v[112:115], 0
    v_mfma_f32_16x16x32_bf16 v[140:143], v[80:83], v[112:115], 0
    v_mfma_f32_16x16x32_bf16 v[132:135], v[68:71], v[116:119], v[132:135]
    v_mfma_f32_16x16x32_bf16 v[140:143], v[84:87], v[116:119], v[140:143]
    v_mfma_f32_16x16x32_bf16 v[132:135], v[72:75], v[120:123], v[132:135]
    v_mfma_f32_16x16x32_bf16 v[140:143], v[88:91], v[120:123], v[140:143]
    v_mfma_f32_16x16x32_bf16 v[132:135], v[76:79], v[124:127], v[132:135]
    v_mfma_f32_16x16x32_bf16 v[140:143], v[92:95], v[124:127], v[140:143]
    v_mov_b32 v10, v7
    v_xor_b32 v11, 64, v7
    v_add_u32 v12, 57344, v7
    v_add_u32 v13, 57344, v11
    s_lshl_b32 s34, s10, 1
    s_add_u32 s34, s34, s11
    s_cmp_ge_u32 s34, 7
    s_cselect_b32 s76, 7, 0
    s_sub_u32 s34, s34, s76
    s_lshl_b32 s34, s34, 11
    s_mul_i32 s76, s3, 14
    ds_write_b128 v63, v[128:131]
    ds_write_b128 v63, v[132:135] offset:256
    s_mov_b32 exec_hi, 0
    ds_write_b128 v63, v[136:139] offset:2048
    ds_write_b128 v63, v[140:143] offset:2304
    s_mov_b32 exec_hi, -1
    s_waitcnt vmcnt(0)
    v_cmp_ne_u64 vcc, s[68:69], v[8:9]
    s_nop 0
    s_cbranch_vccz Lc10
    s_mov_b32 s77, 0
Lp11:
    buffer_load_dwordx2 v[8:9], v6, s[4:7], s71 offen sc1
    s_add_u32 s77, s77, 1
    s_waitcnt vmcnt(0)
    v_cmp_ne_u64 vcc, s[68:69], v[8:9]
    s_cmp_gt_u32 s77, 20000
    s_cbranch_scc1 Lo12
    s_cbranch_vccnz Lp11
Lo12:
Lc10:
    s_cmp_ge_u32 s3, 4
    s_cbranch_scc1 LY
    s_nop 0
    buffer_load_dwordx4 v[16:19], v3, s[4:7], s72 offen offset:0 sc1
    buffer_load_dwordx4 v[20:23], v3, s[4:7], s72 offen offset:1024 sc1
    buffer_load_dwordx4 v[24:27], v3, s[4:7], s72 offen offset:2048 sc1
    buffer_load_dwordx4 v[28:31], v3, s[4:7], s72 offen offset:3072 sc1
    s_add_u32 s72, s72, 4096
    s_cmp_ge_u32 s72, s35
    s_cselect_b32 s36, 28672, 0
    s_sub_u32 s72, s72, s36
    buffer_load_dwordx4 v[32:35], v3, s[4:7], s72 offen offset:0 sc1
    buffer_load_dwordx4 v[36:39], v3, s[4:7], s72 offen offset:1024 sc1
    buffer_load_dwordx4 v[40:43], v3, s[4:7], s72 offen offset:2048 sc1
    buffer_load_dwordx4 v[44:47], v3, s[4:7], s72 offen offset:3072 sc1
    s_add_u32 s72, s72, 4096
    s_cmp_ge_u32 s72, s35
    s_cselect_b32 s36, 28672, 0
    s_sub_u32 s72, s72, s36
    buffer_load_dwordx4 v[48:51], v3, s[4:7], s72 offen offset:0 sc1
    buffer_load_dwordx4 v[52:55], v3, s[4:7], s72 offen offset:1024 sc1
    buffer_load_dwordx4 v[56:59], v3, s[4:7], s72 offen offset:2048 sc1
    buffer_load_dwordx4 v[60:63], v3, s[4:7], s72 offen offset:3072 sc1
    s_add_u32 s72, s72, 4096
    s_cmp_ge_u32 s72, s35
    s_cselect_b32 s36, 28672, 0
    s_sub_u32 s72, s72, s36
    buffer_load_dwordx4 v[64:67], v3, s[4:7], s72 offen offset:0 sc1
    buffer_load_dwordx4 v[68:71], v3, s[4:7], s72 offen offset:1024 sc1
    buffer_load_dwordx4 v[72:75], v3, s[4:7], s72 offen offset:2048 sc1
    s_mul_i32 s73, s11, 229376
    s_lshl_b32 s74, s76, 10
    s_add_u32 s73, s73, s74
    s_add_u32 s73, s73, 2097152
    s_add_u32 s37, s73, 14336
    s_add_u32 s73, s73, s34
    s_lshr_b32 s71, s76, 2
    s_mul_i32 s74, s11, 28
    s_add_u32 s74, s74, s71
    s_lshl_b32 s74, s74, 5
    s_add_u32 s74, s74, 12288
    s_setprio 2
    s_waitcnt lgkmcnt(0)
    s_barrier
    ds_read_b64_tr_b16 v[192:193], v10 offset:0
    ds_read_b64_tr_b16 v[194:195], v10 offset:512
    ds_read_b64_tr_b16 v[196:197], v11 offset:0
    ds_read_b64_tr_b16 v[198:199], v11 offset:512
    ds_read_b64_tr_b16 v[200:201], v12 offset:0
    ds_read_b64_tr_b16 v[202:203], v12 offset:512
    ds_read_b64_tr_b16 v[204:205], v13 offset:0
    ds_read_b64_tr_b16 v[206:207], v13 offset:512
    ds_read_b64_tr_b16 v[208:209], v10 offset:2048
    ds_read_b64_tr_b16 v[210:211], v10 offset:2560
    ds_read_b64_tr_b16 v[212:213], v11 offset:2048
    ds_read_b64_tr_b16 v[214:215], v11 offset:2560
    ds_read_b64_tr_b16 v[216:217], v12 offset:2048
    ds_read_b64_tr_b16 v[218:219], v12 offset:2560
    ds_read_b64_tr_b16 v[220:221], v13 offset:2048
    ds_read_b64_tr_b16 v[222:223], v13 offset:2560
    s_waitcnt vmcnt(14) lgkmcnt(14)
    s_nop 0
    v_mfma_f32_32x32x16_bf16 v[128:143], v[192:195], v[16:19], 0
    ds_read_b64_tr_b16 v[192:193], v10 offset:4096
    ds_read_b64_tr_b16 v[194:195], v10 offset:4608
    buffer_load_dwordx4 v[76:79], v3, s[4:7], s72 offen offset:3072 sc1
    s_add_u32 s72, s72, 4096
    s_cmp_ge_u32 s72, s35
    s_cselect_b32 s36, 28672, 0
    s_sub_u32 s72, s72, s36
    s_waitcnt lgkmcnt(14)
    v_mfma_f32_32x32x16_bf16 v[144:159], v[196:199], v[16:19], 0
    ds_read_b64_tr_b16 v[196:197], v11 offset:4096
    ds_read_b64_tr_b16 v[198:199], v11 offset:4608
    s_waitcnt lgkmcnt(14)
    v_mfma_f32_32x32x16_bf16 v[160:175], v[200:203], v[16:19], 0
    ds_read_b64_tr_b16 v[200:201], v12 offset:4096
    ds_read_b64_tr_b16 v[202:203], v12 offset:4608
    s_waitcnt lgkmcnt(14)
    v_mfma_f32_32x32x16_bf16 v[176:191], v[204:207], v[16:19], 0
    ds_read_b64_tr_b16 v[204:205], v13 offset:4096
    ds_read_b64_tr_b16 v[206:207], v13 offset:4608
    s_waitcnt vmcnt(14) lgkmcnt(14)
    v_mfma_f32_32x32x16_bf16 v[128:143], v[208:211], v[20:23], v[128:143]
    ds_read_b64_tr_b16 v[208:209], v10 offset:6144
    ds_read_b64_tr_b16 v[210:211], v10 offset:6656
    buffer_load_dwordx4 v[80:83], v3, s[4:7], s72 offen offset:0 sc1
    s_waitcnt lgkmcnt(14)
    v_mfma_f32_32x32x16_bf16 v[144:159], v[212:215], v[20:23], v[144:159]
    ds_read_b64_tr_b16 v[212:213], v11 offset:6144
    ds_read_b64_tr_b16 v[214:215], v11 offset:6656
    s_waitcnt lgkmcnt(14)
    v_mfma_f32_32x32x16_bf16 v[160:175], v[216:219], v[20:23], v[160:175]
    ds_read_b64_tr_b16 v[216:217], v12 offset:6144
    ds_read_b64_tr_b16 v[218:219], v12 offset:6656
    s_waitcnt lgkmcnt(14)
    v_mfma_f32_32x32x16_bf16 v[176:191], v[220:223], v[20:23], v[176:191]
    ds_read_b64_tr_b16 v[220:221], v13 offset:6144
    ds_read_b64_tr_b16 v[222:223], v13 offset:6656
    s_waitcnt vmcnt(14) lgkmcnt(14)
    v_mfma_f32_32x32x16_bf16 v[128:143], v[192:195], v[24:27], v[128:143]
    ds_read_b64_tr_b16 v[192:193], v10 offset:8192
    ds_read_b64_tr_b16 v[194:195], v10 offset:8704
    buffer_load_dwordx4 v[84:87], v3, s[4:7], s72 offen offset:1024 sc1
    s_waitcnt lgkmcnt(14)
    v_mfma_f32_32x32x16_bf16 v[144:159], v[196:199], v[24:27], v[144:159]
    ds_read_b64_tr_b16 v[196:197], v11 offset:8192
    ds_read_b64_tr_b16 v[198:199], v11 offset:8704
    s_waitcnt lgkmcnt(14)
    v_mfma_f32_32x32x16_bf16 v[160:175], v[200:203], v[24:27], v[160:175]
    ds_read_b64_tr_b16 v[200:201], v12 offset:8192
    ds_read_b64_tr_b16 v[202:203], v12 offset:8704
    s_waitcnt lgkmcnt(14)
    v_mfma_f32_32x32x16_bf16 v[176:191], v[204:207], v[24:27], v[176:191]
    ds_read_b64_tr_b16 v[204:205], v13 offset:8192
    ds_read_b64_tr_b16 v[206:207], v13 offset:8704
    s_waitcnt vmcnt(14) lgkmcnt(14)
    v_mfma_f32_32x32x16_bf16 v[128:143], v[208:211], v[28:31], v[128:143]
    ds_read_b64_tr_b16 v[208:209], v10 offset:10240
    ds_read_b64_tr_b16 v[210:211], v10 offset:10752
    buffer_load_dwordx4 v[88:91], v3, s[4:7], s72 offen offset:2048 sc1
    s_waitcnt lgkmcnt(14)
    v_mfma_f32_32x32x16_bf16 v[144:159], v[212:215], v[28:31], v[144:159]
    ds_read_b64_tr_b16 v[212:213], v11 offset:10240
    ds_read_b64_tr_b16 v[214:215], v11 offset:10752
    s_waitcnt lgkmcnt(14)
    v_mfma_f32_32x32x16_bf16 v[160:175], v[216:219], v[28:31], v[160:175]
    ds_read_b64_tr_b16 v[216:217], v12 offset:10240
    ds_read_b64_tr_b16 v[218:219], v12 offset:10752
    s_waitcnt lgkmcnt(14)
    v_mfma_f32_32x32x16_bf16 v[176:191], v[220:223], v[28:31], v[176:191]
    ds_read_b64_tr_b16 v[220:221], v13 offset:10240
    ds_read_b64_tr_b16 v[222:223], v13 offset:10752
    s_waitcnt vmcnt(14) lgkmcnt(14)
    v_mfma_f32_32x32x16_bf16 v[128:143], v[192:195], v[32:35], v[128:143]
    ds_read_b64_tr_b16 v[192:193], v10 offset:12288
    ds_read_b64_tr_b16 v[194:195], v10 offset:12800
    buffer_load_dwordx4 v[92:95], v3, s[4:7], s72 offen offset:3072 sc1
    s_add_u32 s72, s72, 4096
    s_cmp_ge_u32 s72, s35
    s_cselect_b32 s36, 28672, 0
    s_sub_u32 s72, s72, s36
    s_waitcnt lgkmcnt(14)
    v_mfma_f32_32x32x16_bf16 v[144:159], v[196:199], v[32:35], v[144:159]
    ds_read_b64_tr_b16 v[196:197], v11 offset:12288
    ds_read_b64_tr_b16 v[198:199], v11 offset:12800
    s_waitcnt lgkmcnt(14)
    v_mfma_f32_32x32x16_bf16 v[160:175], v[200:203], v[32:35], v[160:175]
    ds_read_b64_tr_b16 v[200:201], v12 offset:12288
    ds_read_b64_tr_b16 v[202:203], v12 offset:12800
    s_waitcnt lgkmcnt(14)
    v_mfma_f32_32x32x16_bf16 v[176:191], v[204:207], v[32:35], v[176:191]
    ds_read_b64_tr_b16 v[204:205], v13 offset:12288
    ds_read_b64_tr_b16 v[206:207], v13 offset:12800
    s_waitcnt vmcnt(14) lgkmcnt(14)
    v_mfma_f32_32x32x16_bf16 v[128:143], v[208:211], v[36:39], v[128:143]
    ds_read_b64_tr_b16 v[208:209], v10 offset:14336
    ds_read_b64_tr_b16 v[210:211], v10 offset:14848
    buffer_load_dwordx4 v[96:99], v3, s[4:7], s72 offen offset:0 sc1
    s_waitcnt lgkmcnt(14)
    v_mfma_f32_32x32x16_bf16 v[144:159], v[212:215], v[36:39], v[144:159]
    ds_read_b64_tr_b16 v[212:213], v11 offset:14336
    ds_read_b64_tr_b16 v[214:215], v11 offset:14848
    s_waitcnt lgkmcnt(14)
    v_mfma_f32_32x32x16_bf16 v[160:175], v[216:219], v[36:39], v[160:175]
    ds_read_b64_tr_b16 v[216:217], v12 offset:14336
    ds_read_b64_tr_b16 v[218:219], v12 offset:14848
    s_waitcnt lgkmcnt(14)
    v_mfma_f32_32x32x16_bf16 v[176:191], v[220:223], v[36:39], v[176:191]
    ds_read_b64_tr_b16 v[220:221], v13 offset:14336
    ds_read_b64_tr_b16 v[222:223], v13 offset:14848
    s_waitcnt vmcnt(14) lgkmcnt(14)
    v_mfma_f32_32x32x16_bf16 v[128:143], v[192:195], v[40:43], v[128:143]
    ds_read_b64_tr_b16 v[192:193], v10 offset:16384
    ds_read_b64_tr_b16 v[194:195], v10 offset:16896
    buffer_load_dwordx4 v[100:103], v3, s[4:7], s72 offen offset:1024 sc1
    s_waitcnt lgkmcnt(14)
    v_mfma_f32_32x32x16_bf16 v[144:159], v[196:199], v[40:43], v[144:159]
    ds_read_b64_tr_b16 v[196:197], v11 offset:16384
    ds_read_b64_tr_b16 v[198:199], v11 offset:16896
    s_waitcnt lgkmcnt(14)
    v_mfma_f32_32x32x16_bf16 v[160:175], v[200:203], v[40:43], v[160:175]
    ds_read_b64_tr_b16 v[200:201], v12 offset:16384
    ds_read_b64_tr_b16 v[202:203], v12 offset:16896
    s_waitcnt lgkmcnt(14)
    v_mfma_f32_32x32x16_bf16 v[176:191], v[204:207], v[40:43], v[176:191]
    ds_read_b64_tr_b16 v[204:205], v13 offset:16384
    ds_read_b64_tr_b16 v[206:207], v13 offset:16896
    s_waitcnt vmcnt(14) lgkmcnt(14)
    v_mfma_f32_32x32x16_bf16 v[128:143], v[208:211], v[44:47], v[128:143]
    ds_read_b64_tr_b16 v[208:209], v10 offset:18432
    ds_read_b64_tr_b16 v[210:211], v10 offset:18944
    buffer_load_dwordx4 v[104:107], v3, s[4:7], s72 offen offset:2048 sc1
    s_waitcnt lgkmcnt(14)
    v_mfma_f32_32x32x16_bf16 v[144:159], v[212:215], v[44:47], v[144:159]
    ds_read_b64_tr_b16 v[212:213], v11 offset:18432
    ds_read_b64_tr_b16 v[214:215], v11 offset:18944
    s_waitcnt lgkmcnt(14)
    v_mfma_f32_32x32x16_bf16 v[160:175], v[216:219], v[44:47], v[160:175]
    ds_read_b64_tr_b16 v[216:217], v12 offset:18432
    ds_read_b64_tr_b16 v[218:219], v12 offset:18944
    s_waitcnt lgkmcnt(14)
    v_mfma_f32_32x32x16_bf16 v[176:191], v[220:223], v[44:47], v[176:191]
    ds_read_b64_tr_b16 v[220:221], v13 offset:18432
    ds_read_b64_tr_b16 v[222:223], v13 offset:18944
    s_waitcnt vmcnt(14) lgkmcnt(14)
    v_mfma_f32_32x32x16_bf16 v[128:143], v[192:195], v[48:51], v[128:143]
    ds_read_b64_tr_b16 v[192:193], v10 offset:20480
    ds_read_b64_tr_b16 v[194:195], v10 offset:20992
    buffer_load_dwordx4 v[108:111], v3, s[4:7], s72 offen offset:3072 sc1
    s_add_u32 s72, s72, 4096
    s_cmp_ge_u32 s72, s35
    s_cselect_b32 s36, 28672, 0
    s_sub_u32 s72, s72, s36
    buffer_load_dwordx2 v[14:15], v6, s[4:7], s74 offen sc1
    s_waitcnt lgkmcnt(14)
    v_mfma_f32_32x32x16_bf16 v[144:159], v[196:199], v[48:51], v[144:159]
    ds_read_b64_tr_b16 v[196:197], v11 offset:20480
    ds_read_b64_tr_b16 v[198:199], v11 offset:20992
    s_waitcnt lgkmcnt(14)
    v_mfma_f32_32x32x16_bf16 v[160:175], v[200:203], v[48:51], v[160:175]
    ds_read_b64_tr_b16 v[200:201], v12 offset:20480
    ds_read_b64_tr_b16 v[202:203], v12 offset:20992
    s_waitcnt lgkmcnt(14)
    v_mfma_f32_32x32x16_bf16 v[176:191], v[204:207], v[48:51], v[176:191]
    ds_read_b64_tr_b16 v[204:205], v13 offset:20480
    ds_read_b64_tr_b16 v[206:207], v13 offset:20992
    s_waitcnt vmcnt(15) lgkmcnt(14)
    v_mfma_f32_32x32x16_bf16 v[128:143], v[208:211], v[52:55], v[128:143]
    ds_read_b64_tr_b16 v[208:209], v10 offset:22528
    ds_read_b64_tr_b16 v[210:211], v10 offset:23040
    buffer_load_dwordx4 v[112:115], v3, s[4:7], s72 offen offset:0 sc1
    s_waitcnt lgkmcnt(14)
    v_mfma_f32_32x32x16_bf16 v[144:159], v[212:215], v[52:55], v[144:159]
    ds_read_b64_tr_b16 v[212:213], v11 offset:22528
    ds_read_b64_tr_b16 v[214:215], v11 offset:23040
    s_waitcnt lgkmcnt(14)
    v_mfma_f32_32x32x16_bf16 v[160:175], v[216:219], v[52:55], v[160:175]
    ds_read_b64_tr_b16 v[216:217], v12 offset:22528
    ds_read_b64_tr_b16 v[218:219], v12 offset:23040
    s_waitcnt lgkmcnt(14)
    v_mfma_f32_32x32x16_bf16 v[176:191], v[220:223], v[52:55], v[176:191]
    ds_read_b64_tr_b16 v[220:221], v13 offset:22528
    ds_read_b64_tr_b16 v[222:223], v13 offset:23040
    s_waitcnt vmcnt(15) lgkmcnt(14)
    v_mfma_f32_32x32x16_bf16 v[128:143], v[192:195], v[56:59], v[128:143]
    ds_read_b64_tr_b16 v[192:193], v10 offset:24576
    ds_read_b64_tr_b16 v[194:195], v10 offset:25088
    buffer_load_dwordx4 v[116:119], v3, s[4:7], s72 offen offset:1024 sc1
    s_waitcnt lgkmcnt(14)
    v_mfma_f32_32x32x16_bf16 v[144:159], v[196:199], v[56:59], v[144:159]
    ds_read_b64_tr_b16 v[196:197], v11 offset:24576
    ds_read_b64_tr_b16 v[198:199], v11 offset:25088
    s_waitcnt lgkmcnt(14)
    v_mfma_f32_32x32x16_bf16 v[160:175], v[200:203], v[56:59], v[160:175]
    ds_read_b64_tr_b16 v[200:201], v12 offset:24576
    ds_read_b64_tr_b16 v[202:203], v12 offset:25088
    s_waitcnt lgkmcnt(14)
    v_mfma_f32_32x32x16_bf16 v[176:191], v[204:207], v[56:59], v[176:191]
    ds_read_b64_tr_b16 v[204:205], v13 offset:24576
    ds_read_b64_tr_b16 v[206:207], v13 offset:25088
    s_waitcnt vmcnt(15) lgkmcnt(14)
    v_mfma_f32_32x32x16_bf16 v[128:143], v[208:211], v[60:63], v[128:143]
    ds_read_b64_tr_b16 v[208:209], v10 offset:26624
    ds_read_b64_tr_b16 v[210:211], v10 offset:27136
    buffer_load_dwordx4 v[120:123], v3, s[4:7], s72 offen offset:2048 sc1
    s_waitcnt lgkmcnt(14)
    v_mfma_f32_32x32x16_bf16 v[144:159], v[212:215], v[60:63], v[144:159]
    ds_read_b64_tr_b16 v[212:213], v11 offset:26624
    ds_read_b64_tr_b16 v[214:215], v11 offset:27136
    s_waitcnt lgkmcnt(14)
    v_mfma_f32_32x32x16_bf16 v[160:175], v[216:219], v[60:63], v[160:175]
    ds_read_b64_tr_b16 v[216:217], v12 offset:26624
    ds_read_b64_tr_b16 v[218:219], v12 offset:27136
    s_waitcnt lgkmcnt(14)
    v_mfma_f32_32x32x16_bf16 v[176:191], v[220:223], v[60:63], v[176:191]
    ds_read_b64_tr_b16 v[220:221], v13 offset:26624
    ds_read_b64_tr_b16 v[222:223], v13 offset:27136
    s_waitcnt vmcnt(15) lgkmcnt(14)
    v_mfma_f32_32x32x16_bf16 v[128:143], v[192:195], v[64:67], v[128:143]
    ds_read_b64_tr_b16 v[192:193], v10 offset:28672
    ds_read_b64_tr_b16 v[194:195], v10 offset:29184
    buffer_load_dwordx4 v[124:127], v3, s[4:7], s72 offen offset:3072 sc1
    s_waitcnt lgkmcnt(14)
    v_mfma_f32_32x32x16_bf16 v[144:159], v[196:199], v[64:67], v[144:159]
    ds_read_b64_tr_b16 v[196:197], v11 offset:28672
    ds_read_b64_tr_b16 v[198:199], v11 offset:29184
    s_waitcnt lgkmcnt(14)
    v_mfma_f32_32x32x16_bf16 v[160:175], v[200:203], v[64:67], v[160:175]
    ds_read_b64_tr_b16 v[200:201], v12 offset:28672
    ds_read_b64_tr_b16 v[202:203], v12 offset:29184
    s_waitcnt lgkmcnt(14)
    v_mfma_f32_32x32x16_bf16 v[176:191], v[204:207], v[64:67], v[176:191]
    ds_read_b64_tr_b16 v[204:205], v13 offset:28672
    ds_read_b64_tr_b16 v[206:207], v13 offset:29184
    s_waitcnt vmcnt(15) lgkmcnt(14)
    v_mfma_f32_32x32x16_bf16 v[128:143], v[208:211], v[68:71], v[128:143]
    ds_read_b64_tr_b16 v[208:209], v10 offset:30720
    ds_read_b64_tr_b16 v[210:211], v10 offset:31232
    s_waitcnt lgkmcnt(14)
    v_mfma_f32_32x32x16_bf16 v[144:159], v[212:215], v[68:71], v[144:159]
    ds_read_b64_tr_b16 v[212:213], v11 offset:30720
    ds_read_b64_tr_b16 v[214:215], v11 offset:31232
    s_waitcnt lgkmcnt(14)
    v_mfma_f32_32x32x16_bf16 v[160:175], v[216:219], v[68:71], v[160:175]
    ds_read_b64_tr_b16 v[216:217], v12 offset:30720
    ds_read_b64_tr_b16 v[218:219], v12 offset:31232
    s_waitcnt lgkmcnt(14)
    v_mfma_f32_32x32x16_bf16 v[176:191], v[220:223], v[68:71], v[176:191]
    ds_read_b64_tr_b16 v[220:221], v13 offset:30720
    ds_read_b64_tr_b16 v[222:223], v13 offset:31232
    s_waitcnt vmcnt(14) lgkmcnt(14)
    v_mfma_f32_32x32x16_bf16 v[128:143], v[192:195], v[72:75], v[128:143]
    ds_read_b64_tr_b16 v[192:193], v10 offset:32768
    ds_read_b64_tr_b16 v[194:195], v10 offset:33280
    s_waitcnt vmcnt(4)
    v_cmp_ne_u64 vcc, s[68:69], v[14:15]
    s_nop 0
    s_cbranch_vccz Lc13
    s_mov_b32 s77, 0
Lp14:
    buffer_load_dwordx2 v[14:15], v6, s[4:7], s74 offen sc1
    s_add_u32 s77, s77, 1
    s_waitcnt vmcnt(0)
    v_cmp_ne_u64 vcc, s[68:69], v[14:15]
    s_cmp_gt_u32 s77, 20000
    s_cbranch_scc1 Lo15
    s_cbranch_vccnz Lp14
Lo15:
Lc13:
    buffer_load_dwordx4 v[16:19], v3, s[4:7], s73 offen offset:0 sc1
    s_waitcnt lgkmcnt(14)
    v_mfma_f32_32x32x16_bf16 v[144:159], v[196:199], v[72:75], v[144:159]
    ds_read_b64_tr_b16 v[196:197], v11 offset:32768
    ds_read_b64_tr_b16 v[198:199], v11 offset:33280
    s_waitcnt lgkmcnt(14)
    v_mfma_f32_32x32x16_bf16 v[160:175], v[200:203], v[72:75], v[160:175]
    ds_read_b64_tr_b16 v[200:201], v12 offset:32768
    ds_read_b64_tr_b16 v[202:203], v12 offset:33280
    s_waitcnt lgkmcnt(14)
    v_mfma_f32_32x32x16_bf16 v[176:191], v[204:207], v[72:75], v[176:191]
    ds_read_b64_tr_b16 v[204:205], v13 offset:32768
    ds_read_b64_tr_b16 v[206:207], v13 offset:33280
    s_waitcnt vmcnt(14) lgkmcnt(14)
    v_mfma_f32_32x32x16_bf16 v[128:143], v[208:211], v[76:79], v[128:143]
    ds_read_b64_tr_b16 v[208:209], v10 offset:34816
    ds_read_b64_tr_b16 v[210:211], v10 offset:35328
    buffer_load_dwordx4 v[20:23], v3, s[4:7], s73 offen offset:1024 sc1
    s_add_u32 s73, s73, 2048
    s_cmp_ge_u32 s73, s37
    s_cselect_b32 s36, 14336, 0
    s_sub_u32 s73, s73, s36
    s_waitcnt lgkmcnt(14)
    v_mfma_f32_32x32x16_bf16 v[144:159], v[212:215], v[76:79], v[144:159]
    ds_read_b64_tr_b16 v[212:213], v11 offset:34816
    ds_read_b64_tr_b16 v[214:215], v11 offset:35328
    s_waitcnt lgkmcnt(14)
    v_mfma_f32_32x32x16_bf16 v[160:175], v[216:219], v[76:79], v[160:175]
    ds_read_b64_tr_b16 v[216:217], v12 offset:34816
    ds_read_b64_tr_b16 v[218:219], v12 offset:35328
    s_waitcnt lgkmcnt(14)
    v_mfma_f32_32x32x16_bf16 v[176:191], v[220:223], v[76:79], v[176:191]
    ds_read_b64_tr_b16 v[220:221], v13 offset:34816
    ds_read_b64_tr_b16 v[222:223], v13 offset:35328
    s_waitcnt vmcnt(14) lgkmcnt(14)
    v_mfma_f32_32x32x16_bf16 v[128:143], v[192:195], v[80:83], v[128:143]
    ds_read_b64_tr_b16 v[192:193], v10 offset:36864
    ds_read_b64_tr_b16 v[194:195], v10 offset:37376
    buffer_load_dwordx4 v[24:27], v3, s[4:7], s73 offen offset:0 sc1
    s_waitcnt lgkmcnt(14)
    v_mfma_f32_32x32x16_bf16 v[144:159], v[196:199], v[80:83], v[144:159]
    ds_read_b64_tr_b16 v[196:197], v11 offset:36864
    ds_read_b64_tr_b16 v[198:199], v11 offset:37376
    s_waitcnt lgkmcnt(14)
    v_mfma_f32_32x32x16_bf16 v[160:175], v[200:203], v[80:83], v[160:175]
    ds_read_b64_tr_b16 v[200:201], v12 offset:36864
    ds_read_b64_tr_b16 v[202:203], v12 offset:37376
    s_waitcnt lgkmcnt(14)
    v_mfma_f32_32x32x16_bf16 v[176:191], v[204:207], v[80:83], v[176:191]
    ds_read_b64_tr_b16 v[204:205], v13 offset:36864
    ds_read_b64_tr_b16 v[206:207], v13 offset:37376
    s_waitcnt vmcnt(14) lgkmcnt(14)
    v_mfma_f32_32x32x16_bf16 v[128:143], v[208:211], v[84:87], v[128:143]
    ds_read_b64_tr_b16 v[208:209], v10 offset:38912
    ds_read_b64_tr_b16 v[210:211], v10 offset:39424
    buffer_load_dwordx4 v[28:31], v3, s[4:7], s73 offen offset:1024 sc1
    s_add_u32 s73, s73, 2048
    s_cmp_ge_u32 s73, s37
    s_cselect_b32 s36, 14336, 0
    s_sub_u32 s73, s73, s36
    s_waitcnt lgkmcnt(14)
    v_mfma_f32_32x32x16_bf16 v[144:159], v[212:215], v[84:87], v[144:159]
    ds_read_b64_tr_b16 v[212:213], v11 offset:38912
    ds_read_b64_tr_b16 v[214:215], v11 offset:39424
    s_waitcnt lgkmcnt(14)
    v_mfma_f32_32x32x16_bf16 v[160:175], v[216:219], v[84:87], v[160:175]
    ds_read_b64_tr_b16 v[216:217], v12 offset:38912
    ds_read_b64_tr_b16 v[218:219], v12 offset:39424
    s_waitcnt lgkmcnt(14)
    v_mfma_f32_32x32x16_bf16 v[176:191], v[220:223], v[84:87], v[176:191]
    ds_read_b64_tr_b16 v[220:221], v13 offset:38912
    ds_read_b64_tr_b16 v[222:223], v13 offset:39424
    s_waitcnt vmcnt(14) lgkmcnt(14)
    v_mfma_f32_32x32x16_bf16 v[128:143], v[192:195], v[88:91], v[128:143]
    ds_read_b64_tr_b16 v[192:193], v10 offset:40960
    ds_read_b64_tr_b16 v[194:195], v10 offset:41472
    buffer_load_dwordx4 v[32:35], v3, s[4:7], s73 offen offset:0 sc1
    s_waitcnt lgkmcnt(14)
    v_mfma_f32_32x32x16_bf16 v[144:159], v[196:199], v[88:91], v[144:159]
    ds_read_b64_tr_b16 v[196:197], v11 offset:40960
    ds_read_b64_tr_b16 v[198:199], v11 offset:41472
    s_waitcnt lgkmcnt(14)
    v_mfma_f32_32x32x16_bf16 v[160:175], v[200:203], v[88:91], v[160:175]
    ds_read_b64_tr_b16 v[200:201], v12 offset:40960
    ds_read_b64_tr_b16 v[202:203], v12 offset:41472
    s_waitcnt lgkmcnt(14)
    v_mfma_f32_32x32x16_bf16 v[176:191], v[204:207], v[88:91], v[176:191]
    ds_read_b64_tr_b16 v[204:205], v13 offset:40960
    ds_read_b64_tr_b16 v[206:207], v13 offset:41472
    s_waitcnt vmcnt(14) lgkmcnt(14)
    v_mfma_f32_32x32x16_bf16 v[128:143], v[208:211], v[92:95], v[128:143]
    ds_read_b64_tr_b16 v[208:209], v10 offset:43008
    ds_read_b64_tr_b16 v[210:211], v10 offset:43520
    buffer_load_dwordx4 v[36:39], v3, s[4:7], s73 offen offset:1024 sc1
    s_add_u32 s73, s73, 2048
    s_cmp_ge_u32 s73, s37
    s_cselect_b32 s36, 14336, 0
    s_sub_u32 s73, s73, s36
    s_waitcnt lgkmcnt(14)
    v_mfma_f32_32x32x16_bf16 v[144:159], v[212:215], v[92:95], v[144:159]
    ds_read_b64_tr_b16 v[212:213], v11 offset:43008
    ds_read_b64_tr_b16 v[214:215], v11 offset:43520
    s_waitcnt lgkmcnt(14)
    v_mfma_f32_32x32x16_bf16 v[160:175], v[216:219], v[92:95], v[160:175]
    ds_read_b64_tr_b16 v[216:217], v12 offset:43008
    ds_read_b64_tr_b16 v[218:219], v12 offset:43520
    s_waitcnt lgkmcnt(14)
    v_mfma_f32_32x32x16_bf16 v[176:191], v[220:223], v[92:95], v[176:191]
    ds_read_b64_tr_b16 v[220:221], v13 offset:43008
    ds_read_b64_tr_b16 v[222:223], v13 offset:43520
    s_waitcnt vmcnt(14) lgkmcnt(14)
    v_mfma_f32_32x32x16_bf16 v[128:143], v[192:195], v[96:99], v[128:143]
    ds_read_b64_tr_b16 v[192:193], v10 offset:45056
    ds_read_b64_tr_b16 v[194:195], v10 offset:45568
    buffer_load_dwordx4 v[40:43], v3, s[4:7], s73 offen offset:0 sc1
    s_waitcnt lgkmcnt(14)
    v_mfma_f32_32x32x16_bf16 v[144:159], v[196:199], v[96:99], v[144:159]
    ds_read_b64_tr_b16 v[196:197], v11 offset:45056
    ds_read_b64_tr_b16 v[198:199], v11 offset:45568
    s_waitcnt lgkmcnt(14)
    v_mfma_f32_32x32x16_bf16 v[160:175], v[200:203], v[96:99], v[160:175]
    ds_read_b64_tr_b16 v[200:201], v12 offset:45056
    ds_read_b64_tr_b16 v[202:203], v12 offset:45568
    s_waitcnt lgkmcnt(14)
    v_mfma_f32_32x32x16_bf16 v[176:191], v[204:207], v[96:99], v[176:191]
    ds_read_b64_tr_b16 v[204:205], v13 offset:45056
    ds_read_b64_tr_b16 v[206:207], v13 offset:45568
    s_waitcnt vmcnt(14) lgkmcnt(14)
    v_mfma_f32_32x32x16_bf16 v[128:143], v[208:211], v[100:103], v[128:143]
    ds_read_b64_tr_b16 v[208:209], v10 offset:47104
    ds_read_b64_tr_b16 v[210:211], v10 offset:47616
    buffer_load_dwordx4 v[44:47], v3, s[4:7], s73 offen offset:1024 sc1
    s_add_u32 s73, s73, 2048
    s_cmp_ge_u32 s73, s37
    s_cselect_b32 s36, 14336, 0
    s_sub_u32 s73, s73, s36
    s_waitcnt lgkmcnt(14)
    v_mfma_f32_32x32x16_bf16 v[144:159], v[212:215], v[100:103], v[144:159]
    ds_read_b64_tr_b16 v[212:213], v11 offset:47104
    ds_read_b64_tr_b16 v[214:215], v11 offset:47616
    s_waitcnt lgkmcnt(14)
    v_mfma_f32_32x32x16_bf16 v[160:175], v[216:219], v[100:103], v[160:175]
    ds_read_b64_tr_b16 v[216:217], v12 offset:47104
    ds_read_b64_tr_b16 v[218:219], v12 offset:47616
    s_waitcnt lgkmcnt(14)
    v_mfma_f32_32x32x16_bf16 v[176:191], v[220:223], v[100:103], v[176:191]
    ds_read_b64_tr_b16 v[220:221], v13 offset:47104
    ds_read_b64_tr_b16 v[222:223], v13 offset:47616
    s_waitcnt vmcnt(14) lgkmcnt(14)
    v_mfma_f32_32x32x16_bf16 v[128:143], v[192:195], v[104:107], v[128:143]
    ds_read_b64_tr_b16 v[192:193], v10 offset:49152
    ds_read_b64_tr_b16 v[194:195], v10 offset:49664
    buffer_load_dwordx4 v[48:51], v3, s[4:7], s73 offen offset:0 sc1
    s_waitcnt lgkmcnt(14)
    v_mfma_f32_32x32x16_bf16 v[144:159], v[196:199], v[104:107], v[144:159]
    ds_read_b64_tr_b16 v[196:197], v11 offset:49152
    ds_read_b64_tr_b16 v[198:199], v11 offset:49664
    s_waitcnt lgkmcnt(14)
    v_mfma_f32_32x32x16_bf16 v[160:175], v[200:203], v[104:107], v[160:175]
    ds_read_b64_tr_b16 v[200:201], v12 offset:49152
    ds_read_b64_tr_b16 v[202:203], v12 offset:49664
    s_waitcnt lgkmcnt(14)
    v_mfma_f32_32x32x16_bf16 v[176:191], v[204:207], v[104:107], v[176:191]
    ds_read_b64_tr_b16 v[204:205], v13 offset:49152
    ds_read_b64_tr_b16 v[206:207], v13 offset:49664
    s_waitcnt vmcnt(14) lgkmcnt(14)
    v_mfma_f32_32x32x16_bf16 v[128:143], v[208:211], v[108:111], v[128:143]
    ds_read_b64_tr_b16 v[208:209], v10 offset:51200
    ds_read_b64_tr_b16 v[210:211], v10 offset:51712
    buffer_load_dwordx4 v[52:55], v3, s[4:7], s73 offen offset:1024 sc1
    s_add_u32 s73, s73, 2048
    s_cmp_ge_u32 s73, s37
    s_cselect_b32 s36, 14336, 0
    s_sub_u32 s73, s73, s36
    s_waitcnt lgkmcnt(14)
    v_mfma_f32_32x32x16_bf16 v[144:159], v[212:215], v[108:111], v[144:159]
    ds_read_b64_tr_b16 v[212:213], v11 offset:51200
    ds_read_b64_tr_b16 v[214:215], v11 offset:51712
    s_waitcnt lgkmcnt(14)
    v_mfma_f32_32x32x16_bf16 v[160:175], v[216:219], v[108:111], v[160:175]
    ds_read_b64_tr_b16 v[216:217], v12 offset:51200
    ds_read_b64_tr_b16 v[218:219], v12 offset:51712
    s_waitcnt lgkmcnt(14)
    v_mfma_f32_32x32x16_bf16 v[176:191], v[220:223], v[108:111], v[176:191]
    ds_read_b64_tr_b16 v[220:221], v13 offset:51200
    ds_read_b64_tr_b16 v[222:223], v13 offset:51712
    s_waitcnt vmcnt(13) lgkmcnt(14)
    v_mfma_f32_32x32x16_bf16 v[128:143], v[192:195], v[112:115], v[128:143]
    ds_read_b64_tr_b16 v[192:193], v10 offset:53248
    ds_read_b64_tr_b16 v[194:195], v10 offset:53760
    buffer_load_dwordx4 v[56:59], v3, s[4:7], s73 offen offset:0 sc1
    s_waitcnt lgkmcnt(14)
    v_mfma_f32_32x32x16_bf16 v[144:159], v[196:199], v[112:115], v[144:159]
    ds_read_b64_tr_b16 v[196:197], v11 offset:53248
    ds_read_b64_tr_b16 v[198:199], v11 offset:53760
    s_waitcnt lgkmcnt(14)
    v_mfma_f32_32x32x16_bf16 v[160:175], v[200:203], v[112:115], v[160:175]
    ds_read_b64_tr_b16 v[200:201], v12 offset:53248
    ds_read_b64_tr_b16 v[202:203], v12 offset:53760
    s_waitcnt lgkmcnt(14)
    v_mfma_f32_32x32x16_bf16 v[176:191], v[204:207], v[112:115], v[176:191]
    ds_read_b64_tr_b16 v[204:205], v13 offset:53248
    ds_read_b64_tr_b16 v[206:207], v13 offset:53760
    s_waitcnt vmcnt(13) lgkmcnt(14)
    v_mfma_f32_32x32x16_bf16 v[128:143], v[208:211], v[116:119], v[128:143]
    ds_read_b64_tr_b16 v[208:209], v10 offset:55296
    ds_read_b64_tr_b16 v[210:211], v10 offset:55808
    buffer_load_dwordx4 v[60:63], v3, s[4:7], s73 offen offset:1024 sc1
    s_add_u32 s73, s73, 2048
    s_cmp_ge_u32 s73, s37
    s_cselect_b32 s36, 14336, 0
    s_sub_u32 s73, s73, s36
    s_waitcnt lgkmcnt(14)
    v_mfma_f32_32x32x16_bf16 v[144:159], v[212:215], v[116:119], v[144:159]
    ds_read_b64_tr_b16 v[212:213], v11 offset:55296
    ds_read_b64_tr_b16 v[214:215], v11 offset:55808
    s_waitcnt lgkmcnt(14)
    v_mfma_f32_32x32x16_bf16 v[160:175], v[216:219], v[116:119], v[160:175]
    ds_read_b64_tr_b16 v[216:217], v12 offset:55296
    ds_read_b64_tr_b16 v[218:219], v12 offset:55808
    s_waitcnt lgkmcnt(14)
    v_mfma_f32_32x32x16_bf16 v[176:191], v[220:223], v[116:119], v[176:191]
    ds_read_b64_tr_b16 v[220:221], v13 offset:55296
    ds_read_b64_tr_b16 v[222:223], v13 offset:55808
    s_waitcnt vmcnt(13) lgkmcnt(14)
    v_mfma_f32_32x32x16_bf16 v[128:143], v[192:195], v[120:123], v[128:143]
    buffer_load_dwordx4 v[64:67], v3, s[4:7], s73 offen offset:0 sc1
    s_waitcnt lgkmcnt(12)
    v_mfma_f32_32x32x16_bf16 v[144:159], v[196:199], v[120:123], v[144:159]
    s_waitcnt lgkmcnt(10)
    v_mfma_f32_32x32x16_bf16 v[160:175], v[200:203], v[120:123], v[160:175]
    s_waitcnt lgkmcnt(8)
    v_mfma_f32_32x32x16_bf16 v[176:191], v[204:207], v[120:123], v[176:191]
    s_waitcnt vmcnt(13) lgkmcnt(6)
    v_mfma_f32_32x32x16_bf16 v[128:143], v[208:211], v[124:127], v[128:143]
    buffer_load_dwordx4 v[68:71], v3, s[4:7], s73 offen offset:1024 sc1
    s_add_u32 s73, s73, 2048
    s_cmp_ge_u32 s73, s37
    s_cselect_b32 s36, 14336, 0
    s_sub_u32 s73, s73, s36
    s_add_u32 s73, s73, 114688
    s_add_u32 s37, s37, 114688
    s_waitcnt lgkmcnt(4)
    v_mfma_f32_32x32x16_bf16 v[144:159], v[212:215], v[124:127], v[144:159]
    s_waitcnt lgkmcnt(2)
    v_mfma_f32_32x32x16_bf16 v[160:175], v[216:219], v[124:127], v[160:175]
    s_waitcnt lgkmcnt(0)
    v_mfma_f32_32x32x16_bf16 v[176:191], v[220:223], v[124:127], v[176:191]
    s_setprio 0
    s_mul_i32 s72, s70, 114688
    s_lshl_b32 s71, s13, 12
    s_add_u32 s72, s72, s71
    s_add_u32 s72, s72, 6291456
    v_mov_b32 v9, 0xbfb8aa3b
    v_mul_f32 v128, v9, v128
    v_mul_f32 v129, v9, v129
    v_mul_f32 v130, v9, v130
    v_mul_f32 v131, v9, v131
    v_mul_f32 v132, v9, v132
    v_mul_f32 v133, v9, v133
    v_mul_f32 v134, v9, v134
    v_mul_f32 v135, v9, v135
    v_exp_f32 v128, v128
    v_exp_f32 v129, v129
    v_exp_f32 v130, v130
    v_exp_f32 v131, v131
    v_exp_f32 v132, v132
    v_exp_f32 v133, v133
    v_exp_f32 v134, v134
    v_exp_f32 v135, v135
    v_add_f32 v128, 1.0, v128
    v_add_f32 v129, 1.0, v129
    v_add_f32 v130, 1.0, v130
    v_add_f32 v131, 1.0, v131
    v_add_f32 v132, 1.0, v132
    v_add_f32 v133, 1.0, v133
    v_add_f32 v134, 1.0, v134
    v_add_f32 v135, 1.0, v135
    v_rcp_f32 v128, v128
    v_rcp_f32 v129, v129
    v_rcp_f32 v130, v130
    v_rcp_f32 v131, v131
    v_rcp_f32 v132, v132
    v_rcp_f32 v133, v133
    v_rcp_f32 v134, v134
    v_rcp_f32 v135, v135
    v_mul_f32 v128, v128, v160
    v_mul_f32 v129, v129, v161
    v_mul_f32 v130, v130, v162
    v_mul_f32 v131, v131, v163
    v_mul_f32 v132, v132, v164
    v_mul_f32 v133, v133, v165
    v_mul_f32 v134, v134, v166
    v_mul_f32 v135, v135, v167
    v_cvt_pk_bf16_f32 v128, v128, v129
    v_cvt_pk_bf16_f32 v129, v130, v131
    v_cvt_pk_bf16_f32 v130, v132, v133
    v_cvt_pk_bf16_f32 v131, v134, v135
    buffer_store_dwordx4 v[128:131], v3, s[4:7], s72 offen offset:0 sc1
    v_mul_f32 v136, v9, v136
    v_mul_f32 v137, v9, v137
    v_mul_f32 v138, v9, v138
    v_mul_f32 v139, v9, v139
    v_mul_f32 v140, v9, v140
    v_mul_f32 v141, v9, v141
    v_mul_f32 v142, v9, v142
    v_mul_f32 v143, v9, v143
    v_exp_f32 v136, v136
    v_exp_f32 v137, v137
    v_exp_f32 v138, v138
    v_exp_f32 v139, v139
    v_exp_f32 v140, v140
    v_exp_f32 v141, v141
    v_exp_f32 v142, v142
    v_exp_f32 v143, v143
    v_add_f32 v136, 1.0, v136
    v_add_f32 v137, 1.0, v137
    v_add_f32 v138, 1.0, v138
    v_add_f32 v139, 1.0, v139
    v_add_f32 v140, 1.0, v140
    v_add_f32 v141, 1.0, v141
    v_add_f32 v142, 1.0, v142
    v_add_f32 v143, 1.0, v143
    v_rcp_f32 v136, v136
    v_rcp_f32 v137, v137
    v_rcp_f32 v138, v138
    v_rcp_f32 v139, v139
    v_rcp_f32 v140, v140
    v_rcp_f32 v141, v141
    v_rcp_f32 v142, v142
    v_rcp_f32 v143, v143
    v_mul_f32 v136, v136, v168
    v_mul_f32 v137, v137, v169
    v_mul_f32 v138, v138, v170
    v_mul_f32 v139, v139, v171
    v_mul_f32 v140, v140, v172
    v_mul_f32 v141, v141, v173
    v_mul_f32 v142, v142, v174
    v_mul_f32 v143, v143, v175
    v_cvt_pk_bf16_f32 v136, v136, v137
    v_cvt_pk_bf16_f32 v137, v138, v139
    v_cvt_pk_bf16_f32 v138, v140, v141
    v_cvt_pk_bf16_f32 v139, v142, v143
    buffer_store_dwordx4 v[136:139], v3, s[4:7], s72 offen offset:1024 sc1
    v_mul_f32 v144, v9, v144
    v_mul_f32 v145, v9, v145
    v_mul_f32 v146, v9, v146
    v_mul_f32 v147, v9, v147
    v_mul_f32 v148, v9, v148
    v_mul_f32 v149, v9, v149
    v_mul_f32 v150, v9, v150
    v_mul_f32 v151, v9, v151
    v_exp_f32 v144, v144
    v_exp_f32 v145, v145
    v_exp_f32 v146, v146
    v_exp_f32 v147, v147
    v_exp_f32 v148, v148
    v_exp_f32 v149, v149
    v_exp_f32 v150, v150
    v_exp_f32 v151, v151
    v_add_f32 v144, 1.0, v144
    v_add_f32 v145, 1.0, v145
    v_add_f32 v146, 1.0, v146
    v_add_f32 v147, 1.0, v147
    v_add_f32 v148, 1.0, v148
    v_add_f32 v149, 1.0, v149
    v_add_f32 v150, 1.0, v150
    v_add_f32 v151, 1.0, v151
    v_rcp_f32 v144, v144
    v_rcp_f32 v145, v145
    v_rcp_f32 v146, v146
    v_rcp_f32 v147, v147
    v_rcp_f32 v148, v148
    v_rcp_f32 v149, v149
    v_rcp_f32 v150, v150
    v_rcp_f32 v151, v151
    v_mul_f32 v144, v144, v176
    v_mul_f32 v145, v145, v177
    v_mul_f32 v146, v146, v178
    v_mul_f32 v147, v147, v179
    v_mul_f32 v148, v148, v180
    v_mul_f32 v149, v149, v181
    v_mul_f32 v150, v150, v182
    v_mul_f32 v151, v151, v183
    v_cvt_pk_bf16_f32 v144, v144, v145
    v_cvt_pk_bf16_f32 v145, v146, v147
    v_cvt_pk_bf16_f32 v146, v148, v149
    v_cvt_pk_bf16_f32 v147, v150, v151
    buffer_store_dwordx4 v[144:147], v3, s[4:7], s72 offen offset:2048 sc1
    v_mul_f32 v152, v9, v152
    v_mul_f32 v153, v9, v153
    v_mul_f32 v154, v9, v154
    v_mul_f32 v155, v9, v155
    v_mul_f32 v156, v9, v156
    v_mul_f32 v157, v9, v157
    v_mul_f32 v158, v9, v158
    v_mul_f32 v159, v9, v159
    v_exp_f32 v152, v152
    v_exp_f32 v153, v153
    v_exp_f32 v154, v154
    v_exp_f32 v155, v155
    v_exp_f32 v156, v156
    v_exp_f32 v157, v157
    v_exp_f32 v158, v158
    v_exp_f32 v159, v159
    v_add_f32 v152, 1.0, v152
    v_add_f32 v153, 1.0, v153
    v_add_f32 v154, 1.0, v154
    v_add_f32 v155, 1.0, v155
    v_add_f32 v156, 1.0, v156
    v_add_f32 v157, 1.0, v157
    v_add_f32 v158, 1.0, v158
    v_add_f32 v159, 1.0, v159
    v_rcp_f32 v152, v152
    v_rcp_f32 v153, v153
    v_rcp_f32 v154, v154
    v_rcp_f32 v155, v155
    v_rcp_f32 v156, v156
    v_rcp_f32 v157, v157
    v_rcp_f32 v158, v158
    v_rcp_f32 v159, v159
    v_mul_f32 v152, v152, v184
    v_mul_f32 v153, v153, v185
    v_mul_f32 v154, v154, v186
    v_mul_f32 v155, v155, v187
    v_mul_f32 v156, v156, v188
    v_mul_f32 v157, v157, v189
    v_mul_f32 v158, v158, v190
    v_mul_f32 v159, v159, v191
    v_cvt_pk_bf16_f32 v152, v152, v153
    v_cvt_pk_bf16_f32 v153, v154, v155
    v_cvt_pk_bf16_f32 v154, v156, v157
    v_cvt_pk_bf16_f32 v155, v158, v159
    buffer_store_dwordx4 v[152:155], v3, s[4:7], s72 offen offset:3072 sc1
    s_mul_i32 s72, s70, 28
    s_add_u32 s72, s72, s13
    s_lshl_b32 s72, s72, 5
    s_nop 0
    s_add_u32 s72, s72, 77824
    buffer_load_dwordx4 v[72:75], v3, s[4:7], s73 offen offset:0 sc1
    buffer_load_dwordx4 v[76:79], v3, s[4:7], s73 offen offset:1024 sc1
    s_add_u32 s73, s73, 2048
    s_cmp_ge_u32 s73, s37
    s_cselect_b32 s36, 14336, 0
    s_sub_u32 s73, s73, s36
    buffer_load_dwordx4 v[80:83], v3, s[4:7], s73 offen offset:0 sc1
    buffer_load_dwordx4 v[84:87], v3, s[4:7], s73 offen offset:1024 sc1
    s_add_u32 s73, s73, 2048
    s_cmp_ge_u32 s73, s37
    s_cselect_b32 s36, 14336, 0
    s_sub_u32 s73, s73, s36
    s_lshr_b32 s38, s3, 1
    s_and_b32 s71, s3, 1
    v_and_b32 v8, 15, v1
    v_lshrrev_b32 v9, 4, v1
    v_lshrrev_b32_e64 v10, 1, v8
    v_lshl_add_u32 v10, v9, 2, v10
    v_sub_u32 v10, 1027, v10
    v_lshlrev_b32 v10, 2, v10
    v_and_b32 v11, 1, v8
    v_xor_b32_e64 v11, 1, v11
    v_mul_u32_u24 v11, 4160, v11
    s_mul_i32 s39, s38, 17408
    s_add_u32 s39, s39, 0
    s_lshl_b32 s71, s71, 6
    s_sub_u32 s39, s39, s71
    v_add3_u32 v10, v10, v11, s39
    v_lshlrev_b32 v14, 5, v8
    v_lshlrev_b32 v15, 4, v9
    v_sub_u32 v14, v14, v15
    s_mul_i32 s39, s38, 4608
    s_add_u32 s39, s39, 149616
    s_sub_u32 s39, s39, s71
    v_add_u32 v14, s39, v14
    v_add_u32 v13, -3968, v10
    v_add_u32 v12, -2944, v10
    v_add_u32 v11, -1920, v10
    v_add_u32 v10, -896, v10
    s_mul_i32 s71, s3, 10240
    s_add_u32 s71, s71, 67584
    v_mul_u32_u24 v9, 320, v9
    v_lshl_add_u32 v9, v8, 4, v9
    v_add_u32 v9, s71, v9
    s_barrier
    s_or_b32 s71, s2, s3
    s_cmp_lg_u32 s71, 0
    s_cbranch_scc1 Lnoep
    v_mov_b32 v244, s68
    v_mov_b32 v245, s69
    s_mov_b64 exec, 1
    buffer_store_dwordx2 v[244:245], off, s[4:7], 0 sc1
    s_mov_b64 exec, -1
Lnoep:
    s_nop 0
    ds_read2_b32 v[160:161], v10 offset0:224 offset1:225
    ds_read2_b32 v[162:163], v10 offset0:226 offset1:227
    ds_read_b128 v[164:167], v14 offset:384
    ds_read2_b32 v[168:169], v10 offset0:96 offset1:97
    ds_read2_b32 v[170:171], v10 offset0:98 offset1:99
    ds_read_b128 v[172:175], v14 offset:896
    ds_read2_b32 v[176:177], v11 offset0:224 offset1:225
    ds_read2_b32 v[178:179], v11 offset0:226 offset1:227
    ds_read_b128 v[180:183], v14 offset:1408
    ds_read2_b32 v[184:185], v11 offset0:96 offset1:97
    ds_read2_b32 v[186:187], v11 offset0:98 offset1:99
    ds_read_b128 v[188:191], v14 offset:1920
    ds_read2_b32 v[192:193], v12 offset0:224 offset1:225
    ds_read2_b32 v[194:195], v12 offset0:226 offset1:227
    ds_read_b128 v[196:199], v14 offset:2432
    ds_read2_b32 v[200:201], v12 offset0:96 offset1:97
    ds_read2_b32 v[202:203], v12 offset0:98 offset1:99
    ds_read_b128 v[204:207], v14 offset:2944
    ds_read2_b32 v[208:209], v13 offset0:224 offset1:225
    ds_read2_b32 v[210:211], v13 offset0:226 offset1:227
    ds_read_b128 v[212:215], v14 offset:3456
    ds_read2_b32 v[216:217], v13 offset0:96 offset1:97
    ds_read2_b32 v[218:219], v13 offset0:98 offset1:99
    ds_read_b128 v[220:223], v14 offset:3968
    s_setprio 0
    s_waitcnt lgkmcnt(15)
    v_mfma_f32_16x16x32_bf16 v[128:131], v[160:163], v[164:167], 0
    buffer_load_dwordx4 v[88:91], v3, s[4:7], s73 offen offset:0 sc1
    s_waitcnt lgkmcnt(15)
    v_mfma_f32_16x16x32_bf16 v[132:135], v[168:171], v[164:167], 0
    s_waitcnt lgkmcnt(15)
    v_mfma_f32_16x16x32_bf16 v[132:135], v[160:163], v[172:175], v[132:135]
    buffer_load_dwordx4 v[92:95], v3, s[4:7], s73 offen offset:1024 sc1
    s_add_u32 s73, s73, 2048
    s_cmp_ge_u32 s73, s37
    s_cselect_b32 s36, 14336, 0
    s_sub_u32 s73, s73, s36
    v_mfma_f32_16x16x32_bf16 v[136:139], v[168:171], v[172:175], 0
    s_waitcnt lgkmcnt(15)
    v_mfma_f32_16x16x32_bf16 v[136:139], v[176:179], v[164:167], v[136:139]
    buffer_load_dwordx4 v[96:99], v3, s[4:7], s73 offen offset:0 sc1
    v_mfma_f32_16x16x32_bf16 v[140:143], v[176:179], v[172:175], 0
    s_waitcnt lgkmcnt(15)
    v_mfma_f32_16x16x32_bf16 v[136:139], v[160:163], v[180:183], v[136:139]
    buffer_load_dwordx4 v[100:103], v3, s[4:7], s73 offen offset:1024 sc1
    s_add_u32 s73, s73, 2048
    s_cmp_ge_u32 s73, s37
    s_cselect_b32 s36, 14336, 0
    s_sub_u32 s73, s73, s36
    v_mfma_f32_16x16x32_bf16 v[140:143], v[168:171], v[180:183], v[140:143]
    v_mfma_f32_16x16x32_bf16 v[144:147], v[176:179], v[180:183], 0
    s_waitcnt vmcnt(8)
    v_mov_b32 v240, s68
    v_mov_b32 v241, s69
    s_mov_b64 exec, 1
    buffer_store_dwordx2 v[240:241], off, s[4:7], s72 sc1
    s_mov_b64 exec, -1
    buffer_load_dwordx4 v[104:107], v3, s[4:7], s73 offen offset:0 sc1
    s_waitcnt lgkmcnt(13)
    v_mfma_f32_16x16x32_bf16 v[140:143], v[184:187], v[164:167], v[140:143]
    v_mfma_f32_16x16x32_bf16 v[144:147], v[184:187], v[172:175], v[144:147]
    buffer_load_dwordx4 v[108:111], v3, s[4:7], s73 offen offset:1024 sc1
    s_add_u32 s73, s73, 2048
    s_cmp_ge_u32 s73, s37
    s_cselect_b32 s36, 14336, 0
    s_sub_u32 s73, s73, s36
    v_mfma_f32_16x16x32_bf16 v[148:151], v[184:187], v[180:183], 0
    s_waitcnt lgkmcnt(12)
    s_nop 0
    v_mfma_f32_16x16x32_bf16 v[140:143], v[160:163], v[188:191], v[140:143]
    buffer_load_dwordx4 v[112:115], v3, s[4:7], s73 offen offset:0 sc1
    v_mfma_f32_16x16x32_bf16 v[144:147], v[168:171], v[188:191], v[144:147]
    v_mfma_f32_16x16x32_bf16 v[148:151], v[176:179], v[188:191], v[148:151]
    buffer_load_dwordx4 v[116:119], v3, s[4:7], s73 offen offset:1024 sc1
    s_add_u32 s73, s73, 2048
    s_cmp_ge_u32 s73, s37
    s_cselect_b32 s36, 14336, 0
    s_sub_u32 s73, s73, s36
    v_mfma_f32_16x16x32_bf16 v[152:155], v[184:187], v[188:191], 0
    s_waitcnt lgkmcnt(10)
    s_nop 0
    v_mfma_f32_16x16x32_bf16 v[156:159], v[192:195], v[188:191], 0
    ds_read2_b32 v[188:189], v10 offset0:192 offset1:193
    ds_read2_b32 v[190:191], v10 offset0:194 offset1:195
    buffer_load_dwordx4 v[120:123], v3, s[4:7], s73 offen offset:0 sc1
    s_waitcnt lgkmcnt(11)
    s_nop 0
    v_mfma_f32_16x16x32_bf16 v[156:159], v[184:187], v[196:199], v[156:159]
    ds_read_b128 v[184:187], v14 offset:256
    v_mfma_f32_16x16x32_bf16 v[152:155], v[192:195], v[180:183], v[152:155]
    buffer_load_dwordx4 v[124:127], v3, s[4:7], s73 offen offset:1024 sc1
    s_lshr_b32 s71, s76, 2
    s_mul_i32 s74, s14, 56
    s_add_u32 s74, s74, s71
    s_lshl_b32 s74, s74, 5
    s_add_u32 s74, s74, 77824
    s_mul_i32 s73, s14, 229376
    s_lshl_b32 s71, s76, 10
    s_add_u32 s73, s73, s71
    s_add_u32 s73, s73, 6291456
    s_add_u32 s37, s73, 14336
    s_add_u32 s73, s73, s34
    s_waitcnt lgkmcnt(10)
    v_mfma_f32_16x16x32_bf16 v[156:159], v[200:203], v[180:183], v[156:159]
    ds_read2_b32 v[180:181], v10 offset0:64 offset1:65
    ds_read2_b32 v[182:183], v10 offset0:66 offset1:67
    v_mfma_f32_16x16x32_bf16 v[152:155], v[176:179], v[196:199], v[152:155]
    s_waitcnt lgkmcnt(11)
    s_nop 0
    v_mfma_f32_16x16x32_bf16 v[156:159], v[176:179], v[204:207], v[156:159]
    ds_read_b128 v[176:179], v14 offset:768
    v_mfma_f32_16x16x32_bf16 v[148:151], v[192:195], v[172:175], v[148:151]
    v_mfma_f32_16x16x32_bf16 v[152:155], v[200:203], v[172:175], v[152:155]
    s_waitcnt lgkmcnt(10)
    s_nop 0
    v_mfma_f32_16x16x32_bf16 v[156:159], v[208:211], v[172:175], v[156:159]
    ds_read2_b32 v[172:173], v11 offset0:192 offset1:193
    ds_read2_b32 v[174:175], v11 offset0:194 offset1:195
    buffer_load_dwordx2 v[4:5], v6, s[4:7], s74 offen sc1
    v_mfma_f32_16x16x32_bf16 v[148:151], v[168:171], v[196:199], v[148:151]
    v_mfma_f32_16x16x32_bf16 v[152:155], v[168:171], v[204:207], v[152:155]
    s_waitcnt lgkmcnt(11)
    s_nop 0
    v_mfma_f32_16x16x32_bf16 v[156:159], v[168:171], v[212:215], v[156:159]
    ds_read_b128 v[168:171], v14 offset:1280
    v_mfma_f32_16x16x32_bf16 v[144:147], v[192:195], v[164:167], v[144:147]
    ds_read2_b32 v[192:193], v11 offset0:64 offset1:65
    ds_read2_b32 v[194:195], v11 offset0:66 offset1:67
    v_mfma_f32_16x16x32_bf16 v[144:147], v[160:163], v[196:199], v[144:147]
    ds_read_b128 v[196:199], v14 offset:1792
    v_mfma_f32_16x16x32_bf16 v[148:151], v[200:203], v[164:167], v[148:151]
    ds_read2_b32 v[200:201], v12 offset0:192 offset1:193
    ds_read2_b32 v[202:203], v12 offset0:194 offset1:195
    v_mfma_f32_16x16x32_bf16 v[148:151], v[160:163], v[204:207], v[148:151]
    ds_read_b128 v[204:207], v14 offset:2304
    v_mfma_f32_16x16x32_bf16 v[152:155], v[208:211], v[164:167], v[152:155]
    ds_read2_b32 v[208:209], v12 offset0:64 offset1:65
    ds_read2_b32 v[210:211], v12 offset0:66 offset1:67
    v_mfma_f32_16x16x32_bf16 v[152:155], v[160:163], v[212:215], v[152:155]
    ds_read_b128 v[212:215], v14 offset:2816
    s_waitcnt lgkmcnt(15)
    v_mfma_f32_16x16x32_bf16 v[156:159], v[216:219], v[164:167], v[156:159]
    ds_read2_b32 v[216:217], v13 offset0:192 offset1:193
    ds_read2_b32 v[218:219], v13 offset0:194 offset1:195
    s_waitcnt lgkmcnt(15)
    v_mfma_f32_16x16x32_bf16 v[156:159], v[160:163], v[220:223], v[156:159]
    ds_read_b128 v[164:167], v14 offset:3328
    s_waitcnt lgkmcnt(15)
    v_mfma_f32_16x16x32_bf16 v[128:131], v[188:191], v[184:187], v[128:131]
    ds_read2_b32 v[160:161], v13 offset0:64 offset1:65
    ds_read2_b32 v[162:163], v13 offset0:66 offset1:67
    s_waitcnt lgkmcnt(15)
    v_mfma_f32_16x16x32_bf16 v[132:135], v[180:183], v[184:187], v[132:135]
    ds_read_b128 v[220:223], v14 offset:3840
    s_waitcnt lgkmcnt(15)
    v_mfma_f32_16x16x32_bf16 v[132:135], v[188:191], v[176:179], v[132:135]
    v_mfma_f32_16x16x32_bf16 v[136:139], v[180:183], v[176:179], v[136:139]
    s_waitcnt lgkmcnt(15)
    v_mfma_f32_16x16x32_bf16 v[136:139], v[172:175], v[184:187], v[136:139]
    v_mfma_f32_16x16x32_bf16 v[140:143], v[172:175], v[176:179], v[140:143]
    s_waitcnt lgkmcnt(15)
    v_mfma_f32_16x16x32_bf16 v[136:139], v[188:191], v[168:171], v[136:139]
    v_mfma_f32_16x16x32_bf16 v[140:143], v[180:183], v[168:171], v[140:143]
    v_mfma_f32_16x16x32_bf16 v[144:147], v[172:175], v[168:171], v[144:147]
    s_waitcnt vmcnt(0)
    v_cmp_ne_u64 vcc, s[68:69], v[4:5]
    s_waitcnt lgkmcnt(13)
    v_mfma_f32_16x16x32_bf16 v[140:143], v[192:195], v[184:187], v[140:143]
    v_mfma_f32_16x16x32_bf16 v[144:147], v[192:195], v[176:179], v[144:147]
    s_cbranch_vccnz Le16
    buffer_load_dwordx4 v[224:227], v3, s[4:7], s73 offen offset:0 sc1
Le16:
    v_mfma_f32_16x16x32_bf16 v[148:151], v[192:195], v[168:171], v[148:151]
    s_waitcnt lgkmcnt(12)
    v_mfma_f32_16x16x32_bf16 v[140:143], v[188:191], v[196:199], v[140:143]
    s_cbranch_vccnz Le17
    buffer_load_dwordx4 v[228:231], v3, s[4:7], s73 offen offset:1024 sc1
    s_add_u32 s73, s73, 2048
    s_cmp_ge_u32 s73, s37
    s_cselect_b32 s36, 14336, 0
    s_sub_u32 s73, s73, s36
Le17:
    v_mfma_f32_16x16x32_bf16 v[144:147], v[180:183], v[196:199], v[144:147]
    v_mfma_f32_16x16x32_bf16 v[148:151], v[172:175], v[196:199], v[148:151]
    s_cbranch_vccnz Le18
    buffer_load_dwordx4 v[232:235], v3, s[4:7], s73 offen offset:0 sc1
Le18:
    v_mfma_f32_16x16x32_bf16 v[152:155], v[192:195], v[196:199], v[152:155]
    s_waitcnt lgkmcnt(10)
    v_mfma_f32_16x16x32_bf16 v[156:159], v[200:203], v[196:199], v[156:159]
    ds_read2_b32 v[196:197], v10 offset0:160 offset1:161
    ds_read2_b32 v[198:199], v10 offset0:162 offset1:163
    s_cbranch_vccnz Le19
    buffer_load_dwordx4 v[236:239], v3, s[4:7], s73 offen offset:1024 sc1
    s_add_u32 s73, s73, 2048
    s_cmp_ge_u32 s73, s37
    s_cselect_b32 s36, 14336, 0
    s_sub_u32 s73, s73, s36
Le19:
    s_waitcnt lgkmcnt(11)
    v_mfma_f32_16x16x32_bf16 v[156:159], v[192:195], v[204:207], v[156:159]
    ds_read_b128 v[192:195], v14 offset:128
    v_mfma_f32_16x16x32_bf16 v[152:155], v[200:203], v[168:171], v[152:155]
    s_cbranch_vccnz Le20
    buffer_load_dwordx4 v[240:243], v3, s[4:7], s73 offen offset:0 sc1
Le20:
    s_waitcnt lgkmcnt(10)
    s_nop 0
    v_mfma_f32_16x16x32_bf16 v[156:159], v[208:211], v[168:171], v[156:159]
    ds_read2_b32 v[168:169], v10 offset0:32 offset1:33
    ds_read2_b32 v[170:171], v10 offset0:34 offset1:35
    v_mfma_f32_16x16x32_bf16 v[152:155], v[172:175], v[204:207], v[152:155]
    s_cbranch_vccnz Le21
    buffer_load_dwordx4 v[244:247], v3, s[4:7], s73 offen offset:1024 sc1
    s_add_u32 s73, s73, 2048
    s_cmp_ge_u32 s73, s37
    s_cselect_b32 s36, 14336, 0
    s_sub_u32 s73, s73, s36
Le21:
    s_waitcnt lgkmcnt(11)
    v_mfma_f32_16x16x32_bf16 v[156:159], v[172:175], v[212:215], v[156:159]
    ds_read_b128 v[172:175], v14 offset:640
    v_mfma_f32_16x16x32_bf16 v[148:151], v[200:203], v[176:179], v[148:151]
    s_cbranch_vccnz Le22
    buffer_load_dwordx4 v[248:251], v3, s[4:7], s73 offen offset:0 sc1
Le22:
    v_mfma_f32_16x16x32_bf16 v[152:155], v[208:211], v[176:179], v[152:155]
    s_waitcnt lgkmcnt(10)
    v_mfma_f32_16x16x32_bf16 v[156:159], v[216:219], v[176:179], v[156:159]
    ds_read2_b32 v[176:177], v11 offset0:160 offset1:161
    ds_read2_b32 v[178:179], v11 offset0:162 offset1:163
    s_cbranch_vccnz Le23
    buffer_load_dwordx4 v[252:255], v3, s[4:7], s73 offen offset:1024 sc1
    s_add_u32 s73, s73, 2048
    s_cmp_ge_u32 s73, s37
    s_cselect_b32 s36, 14336, 0
    s_sub_u32 s73, s73, s36
Le23:
    v_mfma_f32_16x16x32_bf16 v[148:151], v[180:183], v[204:207], v[148:151]
    v_mfma_f32_16x16x32_bf16 v[152:155], v[180:183], v[212:215], v[152:155]
    s_waitcnt lgkmcnt(11)
    v_mfma_f32_16x16x32_bf16 v[156:159], v[180:183], v[164:167], v[156:159]
    ds_read_b128 v[180:183], v14 offset:1152
    v_mfma_f32_16x16x32_bf16 v[144:147], v[200:203], v[184:187], v[144:147]
    ds_read2_b32 v[200:201], v11 offset0:32 offset1:33
    ds_read2_b32 v[202:203], v11 offset0:34 offset1:35
    v_mfma_f32_16x16x32_bf16 v[144:147], v[188:191], v[204:207], v[144:147]
    ds_read_b128 v[204:207], v14 offset:1664
    v_mfma_f32_16x16x32_bf16 v[148:151], v[208:211], v[184:187], v[148:151]
    ds_read2_b32 v[208:209], v12 offset0:160 offset1:161
    ds_read2_b32 v[210:211], v12 offset0:162 offset1:163
    v_mfma_f32_16x16x32_bf16 v[148:151], v[188:191], v[212:215], v[148:151]
    ds_read_b128 v[212:215], v14 offset:2176
    v_mfma_f32_16x16x32_bf16 v[152:155], v[216:219], v[184:187], v[152:155]
    ds_read2_b32 v[216:217], v12 offset0:32 offset1:33
    ds_read2_b32 v[218:219], v12 offset0:34 offset1:35
    v_mfma_f32_16x16x32_bf16 v[152:155], v[188:191], v[164:167], v[152:155]
    ds_read_b128 v[164:167], v14 offset:2688
    s_waitcnt lgkmcnt(15)
    v_mfma_f32_16x16x32_bf16 v[156:159], v[160:163], v[184:187], v[156:159]
    ds_read2_b32 v[160:161], v13 offset0:160 offset1:161
    ds_read2_b32 v[162:163], v13 offset0:162 offset1:163
    s_waitcnt lgkmcnt(15)
    v_mfma_f32_16x16x32_bf16 v[156:159], v[188:191], v[220:223], v[156:159]
    ds_read_b128 v[184:187], v14 offset:3200
    s_waitcnt lgkmcnt(15)
    v_mfma_f32_16x16x32_bf16 v[128:131], v[196:199], v[192:195], v[128:131]
    ds_read2_b32 v[188:189], v13 offset0:32 offset1:33
    ds_read2_b32 v[190:191], v13 offset0:34 offset1:35
    s_waitcnt lgkmcnt(15)
    v_mfma_f32_16x16x32_bf16 v[132:135], v[168:171], v[192:195], v[132:135]
    ds_read_b128 v[220:223], v14 offset:3712
    s_waitcnt lgkmcnt(15)
    v_mfma_f32_16x16x32_bf16 v[132:135], v[196:199], v[172:175], v[132:135]
    v_mfma_f32_16x16x32_bf16 v[136:139], v[168:171], v[172:175], v[136:139]
    s_waitcnt lgkmcnt(15)
    v_mfma_f32_16x16x32_bf16 v[136:139], v[176:179], v[192:195], v[136:139]
    v_mfma_f32_16x16x32_bf16 v[140:143], v[176:179], v[172:175], v[140:143]
    s_waitcnt lgkmcnt(15)
    v_mfma_f32_16x16x32_bf16 v[136:139], v[196:199], v[180:183], v[136:139]
    v_mfma_f32_16x16x32_bf16 v[140:143], v[168:171], v[180:183], v[140:143]
    v_mfma_f32_16x16x32_bf16 v[144:147], v[176:179], v[180:183], v[144:147]
    s_waitcnt lgkmcnt(13)
    v_mfma_f32_16x16x32_bf16 v[140:143], v[200:203], v[192:195], v[140:143]
    v_mfma_f32_16x16x32_bf16 v[144:147], v[200:203], v[172:175], v[144:147]
    v_mfma_f32_16x16x32_bf16 v[148:151], v[200:203], v[180:183], v[148:151]
    s_waitcnt lgkmcnt(12)
    s_nop 0
    v_mfma_f32_16x16x32_bf16 v[140:143], v[196:199], v[204:207], v[140:143]
    v_mfma_f32_16x16x32_bf16 v[144:147], v[168:171], v[204:207], v[144:147]
    v_mfma_f32_16x16x32_bf16 v[148:151], v[176:179], v[204:207], v[148:151]
    v_mfma_f32_16x16x32_bf16 v[152:155], v[200:203], v[204:207], v[152:155]
    s_waitcnt lgkmcnt(10)
    v_mfma_f32_16x16x32_bf16 v[156:159], v[208:211], v[204:207], v[156:159]
    ds_read2_b32 v[204:205], v10 offset0:128 offset1:129
    ds_read2_b32 v[206:207], v10 offset0:130 offset1:131
    s_waitcnt lgkmcnt(11)
    v_mfma_f32_16x16x32_bf16 v[156:159], v[200:203], v[212:215], v[156:159]
    ds_read_b128 v[200:203], v14 offset:0
    v_mfma_f32_16x16x32_bf16 v[152:155], v[208:211], v[180:183], v[152:155]
    s_waitcnt lgkmcnt(10)
    s_nop 0
    v_mfma_f32_16x16x32_bf16 v[156:159], v[216:219], v[180:183], v[156:159]
    ds_read2_b32 v[180:181], v10 offset0:0 offset1:1
    ds_read2_b32 v[182:183], v10 offset0:2 offset1:3
    v_mfma_f32_16x16x32_bf16 v[152:155], v[176:179], v[212:215], v[152:155]
    s_waitcnt lgkmcnt(11)
    s_nop 0
    v_mfma_f32_16x16x32_bf16 v[156:159], v[176:179], v[164:167], v[156:159]
    ds_read_b128 v[176:179], v14 offset:512
    v_mfma_f32_16x16x32_bf16 v[148:151], v[208:211], v[172:175], v[148:151]
    v_mfma_f32_16x16x32_bf16 v[152:155], v[216:219], v[172:175], v[152:155]
    s_waitcnt lgkmcnt(10)
    s_nop 0
    v_mfma_f32_16x16x32_bf16 v[156:159], v[160:163], v[172:175], v[156:159]
    ds_read2_b32 v[172:173], v11 offset0:128 offset1:129
    ds_read2_b32 v[174:175], v11 offset0:130 offset1:131
    v_mfma_f32_16x16x32_bf16 v[148:151], v[168:171], v[212:215], v[148:151]
    v_mfma_f32_16x16x32_bf16 v[152:155], v[168:171], v[164:167], v[152:155]
    s_waitcnt lgkmcnt(11)
    s_nop 0
    v_mfma_f32_16x16x32_bf16 v[156:159], v[168:171], v[184:187], v[156:159]
    ds_read_b128 v[168:171], v14 offset:1024
    v_mfma_f32_16x16x32_bf16 v[144:147], v[208:211], v[192:195], v[144:147]
    ds_read2_b32 v[208:209], v11 offset0:0 offset1:1
    ds_read2_b32 v[210:211], v11 offset0:2 offset1:3
    v_mfma_f32_16x16x32_bf16 v[144:147], v[196:199], v[212:215], v[144:147]
    ds_read_b128 v[212:215], v14 offset:1536
    v_mfma_f32_16x16x32_bf16 v[148:151], v[216:219], v[192:195], v[148:151]
    ds_read2_b32 v[216:217], v12 offset0:128 offset1:129
    ds_read2_b32 v[218:219], v12 offset0:130 offset1:131
    v_mfma_f32_16x16x32_bf16 v[148:151], v[196:199], v[164:167], v[148:151]
    ds_read_b128 v[164:167], v14 offset:2048
    v_mfma_f32_16x16x32_bf16 v[152:155], v[160:163], v[192:195], v[152:155]
    ds_read2_b32 v[160:161], v12 offset0:0 offset1:1
    ds_read2_b32 v[162:163], v12 offset0:2 offset1:3
    v_mfma_f32_16x16x32_bf16 v[152:155], v[196:199], v[184:187], v[152:155]
    ds_read_b128 v[184:187], v14 offset:2560
    s_waitcnt lgkmcnt(15)
    v_mfma_f32_16x16x32_bf16 v[156:159], v[188:191], v[192:195], v[156:159]
    ds_read2_b32 v[188:189], v13 offset0:128 offset1:129
    ds_read2_b32 v[190:191], v13 offset0:130 offset1:131
    s_waitcnt lgkmcnt(15)
    v_mfma_f32_16x16x32_bf16 v[156:159], v[196:199], v[220:223], v[156:159]
    ds_read_b128 v[192:195], v14 offset:3072
    s_waitcnt lgkmcnt(15)
    v_mfma_f32_16x16x32_bf16 v[128:131], v[204:207], v[200:203], v[128:131]
    ds_read2_b32 v[196:197], v13 offset0:0 offset1:1
    ds_read2_b32 v[198:199], v13 offset0:2 offset1:3
    s_waitcnt lgkmcnt(15)
    v_mfma_f32_16x16x32_bf16 v[132:135], v[180:183], v[200:203], v[132:135]
    ds_read_b128 v[220:223], v14 offset:3584
    s_waitcnt lgkmcnt(15)
    v_mfma_f32_16x16x32_bf16 v[132:135], v[204:207], v[176:179], v[132:135]
    v_mfma_f32_16x16x32_bf16 v[136:139], v[180:183], v[176:179], v[136:139]
    s_waitcnt lgkmcnt(15)
    v_mfma_f32_16x16x32_bf16 v[136:139], v[172:175], v[200:203], v[136:139]
    v_mfma_f32_16x16x32_bf16 v[140:143], v[172:175], v[176:179], v[140:143]
    s_waitcnt lgkmcnt(15)
    v_mfma_f32_16x16x32_bf16 v[136:139], v[204:207], v[168:171], v[136:139]
    v_mfma_f32_16x16x32_bf16 v[140:143], v[180:183], v[168:171], v[140:143]
    v_mfma_f32_16x16x32_bf16 v[144:147], v[172:175], v[168:171], v[144:147]
    s_waitcnt lgkmcnt(13)
    v_mfma_f32_16x16x32_bf16 v[140:143], v[208:211], v[200:203], v[140:143]
    v_mfma_f32_16x16x32_bf16 v[144:147], v[208:211], v[176:179], v[144:147]
    v_mfma_f32_16x16x32_bf16 v[148:151], v[208:211], v[168:171], v[148:151]
    s_waitcnt lgkmcnt(12)
    s_nop 0
    v_mfma_f32_16x16x32_bf16 v[140:143], v[204:207], v[212:215], v[140:143]
    v_mfma_f32_16x16x32_bf16 v[144:147], v[180:183], v[212:215], v[144:147]
    v_mfma_f32_16x16x32_bf16 v[148:151], v[172:175], v[212:215], v[148:151]
    v_mfma_f32_16x16x32_bf16 v[152:155], v[208:211], v[212:215], v[152:155]
    s_waitcnt lgkmcnt(10)
    v_mfma_f32_16x16x32_bf16 v[156:159], v[216:219], v[212:215], v[156:159]
    s_waitcnt lgkmcnt(9)
    v_mfma_f32_16x16x32_bf16 v[156:159], v[208:211], v[164:167], v[156:159]
    v_mfma_f32_16x16x32_bf16 v[152:155], v[216:219], v[168:171], v[152:155]
    s_waitcnt lgkmcnt(7)
    v_mfma_f32_16x16x32_bf16 v[156:159], v[160:163], v[168:171], v[156:159]
    v_mfma_f32_16x16x32_bf16 v[152:155], v[172:175], v[164:167], v[152:155]
    s_waitcnt lgkmcnt(6)
    v_mfma_f32_16x16x32_bf16 v[156:159], v[172:175], v[184:187], v[156:159]
    v_mfma_f32_16x16x32_bf16 v[148:151], v[216:219], v[176:179], v[148:151]
    v_mfma_f32_16x16x32_bf16 v[152:155], v[160:163], v[176:179], v[152:155]
    s_waitcnt lgkmcnt(4)
    v_mfma_f32_16x16x32_bf16 v[156:159], v[188:191], v[176:179], v[156:159]
    v_mfma_f32_16x16x32_bf16 v[148:151], v[180:183], v[164:167], v[148:151]
    v_mfma_f32_16x16x32_bf16 v[152:155], v[180:183], v[184:187], v[152:155]
    s_waitcnt lgkmcnt(3)
    v_mfma_f32_16x16x32_bf16 v[156:159], v[180:183], v[192:195], v[156:159]
    v_mfma_f32_16x16x32_bf16 v[144:147], v[216:219], v[200:203], v[144:147]
    v_mfma_f32_16x16x32_bf16 v[144:147], v[204:207], v[164:167], v[144:147]
    v_mfma_f32_16x16x32_bf16 v[148:151], v[160:163], v[200:203], v[148:151]
    v_mfma_f32_16x16x32_bf16 v[148:151], v[204:207], v[184:187], v[148:151]
    v_mfma_f32_16x16x32_bf16 v[152:155], v[188:191], v[200:203], v[152:155]
    v_mfma_f32_16x16x32_bf16 v[152:155], v[204:207], v[192:195], v[152:155]
    s_waitcnt lgkmcnt(1)
    v_mfma_f32_16x16x32_bf16 v[156:159], v[196:199], v[200:203], v[156:159]
    s_waitcnt lgkmcnt(0)
    v_mfma_f32_16x16x32_bf16 v[156:159], v[204:207], v[220:223], v[156:159]
    s_barrier
    s_nop 0
    ds_write_b128 v9, v[128:131] offset:0
    ds_write_b128 v9, v[132:135] offset:1280
    ds_write_b128 v9, v[136:139] offset:2560
    ds_write_b128 v9, v[140:143] offset:3840
    ds_write_b128 v9, v[144:147] offset:5120
    ds_write_b128 v9, v[148:151] offset:6400
    ds_write_b128 v9, v[152:155] offset:7680
    ds_write_b128 v9, v[156:159] offset:8960
    s_cbranch_vccz Lha_ok
    s_mov_b32 s77, 0
Lp24:
    buffer_load_dwordx2 v[4:5], v6, s[4:7], s74 offen sc1
    s_add_u32 s77, s77, 1
    s_waitcnt vmcnt(0)
    v_cmp_ne_u64 vcc, s[68:69], v[4:5]
    s_cmp_gt_u32 s77, 20000
    s_cbranch_scc1 Lo25
    s_cbranch_vccnz Lp24
Lo25:
    buffer_load_dwordx4 v[224:227], v3, s[4:7], s73 offen offset:0 sc1
    buffer_load_dwordx4 v[228:231], v3, s[4:7], s73 offen offset:1024 sc1
    s_add_u32 s73, s73, 2048
    s_cmp_ge_u32 s73, s37
    s_cselect_b32 s36, 14336, 0
    s_sub_u32 s73, s73, s36
    buffer_load_dwordx4 v[232:235], v3, s[4:7], s73 offen offset:0 sc1
    buffer_load_dwordx4 v[236:239], v3, s[4:7], s73 offen offset:1024 sc1
    s_add_u32 s73, s73, 2048
    s_cmp_ge_u32 s73, s37
    s_cselect_b32 s36, 14336, 0
    s_sub_u32 s73, s73, s36
    buffer_load_dwordx4 v[240:243], v3, s[4:7], s73 offen offset:0 sc1
    buffer_load_dwordx4 v[244:247], v3, s[4:7], s73 offen offset:1024 sc1
    s_add_u32 s73, s73, 2048
    s_cmp_ge_u32 s73, s37
    s_cselect_b32 s36, 14336, 0
    s_sub_u32 s73, s73, s36
    buffer_load_dwordx4 v[248:251], v3, s[4:7], s73 offen offset:0 sc1
    buffer_load_dwordx4 v[252:255], v3, s[4:7], s73 offen offset:1024 sc1
    s_add_u32 s73, s73, 2048
    s_cmp_ge_u32 s73, s37
    s_cselect_b32 s36, 14336, 0
    s_sub_u32 s73, s73, s36
Lha_ok:
    buffer_load_dwordx4 v[160:163], v3, s[4:7], s73 offen offset:0 sc1
    buffer_load_dwordx4 v[164:167], v3, s[4:7], s73 offen offset:1024 sc1
    s_add_u32 s73, s73, 2048
    s_cmp_ge_u32 s73, s37
    s_cselect_b32 s36, 14336, 0
    s_sub_u32 s73, s73, s36
    buffer_load_dwordx4 v[168:171], v3, s[4:7], s73 offen offset:0 sc1
    buffer_load_dwordx4 v[172:175], v3, s[4:7], s73 offen offset:1024 sc1
    s_add_u32 s73, s73, 2048
    s_cmp_ge_u32 s73, s37
    s_cselect_b32 s36, 14336, 0
    s_sub_u32 s73, s73, s36
    buffer_load_dwordx4 v[176:179], v3, s[4:7], s73 offen offset:0 sc1
    buffer_load_dwordx4 v[180:183], v3, s[4:7], s73 offen offset:1024 sc1
    s_add_u32 s73, s73, 2048
    s_cmp_ge_u32 s73, s37
    s_cselect_b32 s36, 14336, 0
    s_sub_u32 s73, s73, s36
    s_nop 0
    s_add_u32 s73, s73, 114688
    s_add_u32 s37, s37, 114688
    s_mul_i32 s71, s3, 1280
    s_add_u32 s71, s71, 67584
    v_and_b32 v8, 3, v1
    v_mul_u32_u24 v8, 320, v8
    v_lshrrev_b32 v9, 2, v1
    v_lshl_add_u32 v8, v9, 4, v8
    v_add_u32 v8, s71, v8
    s_lshl_b32 s71, s3, 9
    s_add_u32 s71, s71, 149984
    v_lshl_add_u32 v10, v1, 3, s71
    s_lshl_b32 s71, s75, 16
    s_and_b32 s75, s75, 0xffff0000
    s_add_u32 s74, s74, 896
    s_lshl_b32 s70, s15, 13
    s_lshl_b32 s72, s3, 10
    s_add_u32 s70, s70, s72
    s_add_u32 s70, s70, 4194304
    s_waitcnt lgkmcnt(0)
    s_barrier
    s_branch Ljoin2
LY:
    s_mul_i32 s73, s11, 229376
    s_lshl_b32 s74, s76, 10
    s_add_u32 s73, s73, s74
    s_add_u32 s73, s73, 2097152
    s_add_u32 s37, s73, 14336
    s_add_u32 s73, s73, s34
    s_lshr_b32 s71, s76, 2
    s_mul_i32 s74, s11, 28
    s_add_u32 s74, s74, s71
    s_lshl_b32 s74, s74, 5
    s_add_u32 s74, s74, 12288
    s_waitcnt lgkmcnt(0)
    s_barrier
    buffer_load_dwordx2 v[14:15], v6, s[4:7], s74 offen sc1
    s_cmp_ge_u32 s3, 6
    s_cbranch_scc1 LYu
    s_and_b32 s71, s3, 1
    s_mul_i32 s77, s71, 17408
    s_add_u32 s77, s77, 0
    v_add_u32_e64 v128, s77, v3
    s_mul_i32 s71, s71, 1536
    s_add_u32 s71, s71, 158720
    ds_read_b128 v[144:147], v128 offset:0
    ds_read_b128 v[148:151], v128 offset:4352
    ds_read_b128 v[152:155], v128 offset:8704
    ds_read_b128 v[156:159], v128 offset:13056
    ds_read_b128 v[160:163], v128 offset:1024
    ds_read_b128 v[164:167], v128 offset:5376
    ds_read_b128 v[168:171], v128 offset:9728
    ds_read_b128 v[172:175], v128 offset:14080
    ds_read_b128 v[176:179], v128 offset:2048
    ds_read_b128 v[180:183], v128 offset:6400
    ds_read_b128 v[184:187], v128 offset:10752
    ds_read_b128 v[188:191], v128 offset:15104
    buffer_load_dwordx4 v[16:19], v3, s[4:7], s72 offen offset:0 sc1
    buffer_load_dwordx4 v[20:23], v3, s[4:7], s72 offen offset:1024 sc1
    buffer_load_dwordx4 v[24:27], v3, s[4:7], s72 offen offset:2048 sc1
    v_and_b32 v129, 31, v1
    v_lshrrev_b32 v130, 5, v1
    v_lshlrev_b32 v131, 4, v129
    v_lshl_add_u32 v131, v130, 3, v131
    v_add_u32 v131, s71, v131
    v_sub_u32 v132, 3, v130
    v_lshlrev_b32 v132, v132, v129
    v_lshl_add_u32 v132, v130, 8, v132
    v_add_u32 v132, s71, v132
    v_mul_u32_u24 v133, 124, v130
    v_add_u32 v133, v132, v133
    v_lshlrev_b32 v134, 1, v129
    v_lshl_add_u32 v134, v130, 8, v134
    v_add_u32 v134, s71, v134
    s_waitcnt lgkmcnt(8)
    v_add_f32 v144, v144, v148
    v_add_f32 v145, v145, v149
    v_add_f32 v146, v146, v150
    v_add_f32 v147, v147, v151
    v_add_f32 v152, v152, v156
    v_add_f32 v153, v153, v157
    v_add_f32 v154, v154, v158
    v_add_f32 v155, v155, v159
    v_add_f32 v144, v144, v152
    v_add_f32 v145, v145, v153
    v_add_f32 v146, v146, v154
    v_add_f32_e64 v147, v147, v155
    v_cvt_pk_bf16_f32 v144, v144, v145
    v_cvt_pk_bf16_f32 v145, v146, v147
    ds_write_b64 v131, v[144:145]
    s_waitcnt lgkmcnt(5)
    v_add_f32 v160, v160, v164
    v_add_f32 v161, v161, v165
    v_add_f32 v162, v162, v166
    v_add_f32 v163, v163, v167
    v_add_f32 v168, v168, v172
    v_add_f32 v169, v169, v173
    v_add_f32 v170, v170, v174
    v_add_f32 v171, v171, v175
    v_add_f32 v160, v160, v168
    v_add_f32 v161, v161, v169
    v_add_f32 v162, v162, v170
    v_add_f32_e64 v163, v163, v171
    v_cvt_pk_bf16_f32 v160, v160, v161
    v_cvt_pk_bf16_f32 v161, v162, v163
    ds_write_b32 v132, v160 offset:512
    ds_write_b32 v133, v161 offset:516
    s_waitcnt lgkmcnt(3)
    v_add_f32 v176, v176, v180
    v_add_f32 v177, v177, v181
    v_add_f32 v178, v178, v182
    v_add_f32 v179, v179, v183
    v_add_f32 v184, v184, v188
    v_add_f32 v185, v185, v189
    v_add_f32 v186, v186, v190
    v_add_f32 v187, v187, v191
    v_add_f32 v176, v176, v184
    v_add_f32 v177, v177, v185
    v_add_f32 v178, v178, v186
    v_add_f32_e64 v179, v179, v187
    v_cvt_pk_bf16_f32 v176, v176, v177
    v_cvt_pk_bf16_f32 v177, v178, v179
    ds_write_b16 v134, v176 offset:1024
    ds_write_b16_d16_hi v134, v176 offset:1088
    ds_write_b16 v134, v177 offset:1152
    ds_write_b16_d16_hi v134, v177 offset:1216
    s_waitcnt vmcnt(2)
    buffer_load_dwordx4 v[28:31], v3, s[4:7], s72 offen offset:3072 sc1
    s_add_u32 s72, s72, 4096
    s_cmp_ge_u32 s72, s35
    s_cselect_b32 s36, 28672, 0
    s_sub_u32 s72, s72, s36
    s_waitcnt vmcnt(2)
    buffer_load_dwordx4 v[32:35], v3, s[4:7], s72 offen offset:0 sc1
    s_waitcnt vmcnt(2)
    buffer_load_dwordx4 v[36:39], v3, s[4:7], s72 offen offset:1024 sc1
    v_lshlrev_b32 v135, 3, v1
    v_sub_u32 v135, 2047, v135
    v_cvt_f32_u32 v136, v135
    s_sub_u32 s71, s71, 34048
    v_mov_b32 v137, s71
    v_mov_b32 v140, 0
    v_mov_b32 v141, 0
    v_mov_b32 v142, 0
    v_mov_b32 v143, 0
    v_mov_b32 v138, v136
    v_add_f32 v139, -1.0, v136
    v_cvt_pk_bf16_f32 v138, v138, v139
    v_mad_u32_u16 v192, v138, 2, v137
    v_mad_u32_u16 v193, v138, 2, v137 op_sel:[1,0,0,0]
    v_add_f32_e64 v138, -2.0, v136
    v_add_f32 v139, -3.0, v136
    v_cvt_pk_bf16_f32 v138, v138, v139
    v_mad_u32_u16 v194, v138, 2, v137
    v_mad_u32_u16 v195, v138, 2, v137 op_sel:[1,0,0,0]
    v_add_f32_e64 v138, -4.0, v136
    v_add_f32 v139, -5.0, v136
    v_cvt_pk_bf16_f32 v138, v138, v139
    v_mad_u32_u16 v196, v138, 2, v137
    v_mad_u32_u16 v197, v138, 2, v137 op_sel:[1,0,0,0]
    v_add_f32 v138, -6.0, v136
    v_add_f32 v139, -7.0, v136
    v_cvt_pk_bf16_f32 v138, v138, v139
    v_mad_u32_u16 v198, v138, 2, v137
    v_mad_u32_u16 v199, v138, 2, v137 op_sel:[1,0,0,0]
    v_add_f32 v138, -8.0, v136
    v_add_f32 v139, -9.0, v136
    v_cvt_pk_bf16_f32 v138, v138, v139
    v_mad_u32_u16 v200, v138, 2, v137
    ds_read_u16 v192, v192
    ds_read_u16 v193, v193
    ds_read_u16 v194, v194
    ds_read_u16 v195, v195
    ds_read_u16 v196, v196
    ds_read_u16 v197, v197
    ds_read_u16 v198, v198
    ds_read_u16 v199, v199
    ds_read_u16 v200, v200
    s_waitcnt vmcnt(2)
    buffer_load_dwordx4 v[40:43], v3, s[4:7], s72 offen offset:2048 sc1
    s_waitcnt vmcnt(2)
    buffer_load_dwordx4 v[44:47], v3, s[4:7], s72 offen offset:3072 sc1
    s_add_u32 s72, s72, 4096
    s_cmp_ge_u32 s72, s35
    s_cselect_b32 s36, 28672, 0
    s_sub_u32 s72, s72, s36
    s_waitcnt vmcnt(2)
    buffer_load_dwordx4 v[48:51], v3, s[4:7], s72 offen offset:0 sc1
    s_waitcnt lgkmcnt(0)
    v_lshl_or_b32 v224, v193, 16, v192
    v_lshl_or_b32 v228, v194, 16, v193
    v_lshl_or_b32 v225, v195, 16, v194
    v_lshl_or_b32 v229, v196, 16, v195
    v_lshl_or_b32 v226, v197, 16, v196
    v_lshl_or_b32 v230, v198, 16, v197
    v_lshl_or_b32 v227, v199, 16, v198
    v_lshl_or_b32 v231, v200, 16, v199
    ds_write_b128 v128, v[224:227] offset:0
    ds_write_b128 v128, v[228:231] offset:4160
    v_add_f32 v138, -512.0, v136
    v_add_f32 v139, -513.0, v136
    v_cvt_pk_bf16_f32 v138, v138, v139
    v_mad_u32_u16 v208, v138, 2, v137
    v_mad_u32_u16 v209, v138, 2, v137 op_sel:[1,0,0,0]
    v_add_f32 v138, -514.0, v136
    v_add_f32 v139, -515.0, v136
    v_cvt_pk_bf16_f32 v138, v138, v139
    v_mad_u32_u16 v210, v138, 2, v137
    v_mad_u32_u16 v211, v138, 2, v137 op_sel:[1,0,0,0]
    v_add_f32 v138, -516.0, v136
    v_add_f32 v139, -517.0, v136
    v_cvt_pk_bf16_f32 v138, v138, v139
    v_mad_u32_u16 v212, v138, 2, v137
    v_mad_u32_u16 v213, v138, 2, v137 op_sel:[1,0,0,0]
    v_add_f32 v138, -518.0, v136
    v_add_f32 v139, -519.0, v136
    v_cvt_pk_bf16_f32 v138, v138, v139
    v_mad_u32_u16 v214, v138, 2, v137
    v_mad_u32_u16 v215, v138, 2, v137 op_sel:[1,0,0,0]
    v_add_f32 v138, -520.0, v136
    v_add_f32 v139, -521.0, v136
    v_cvt_pk_bf16_f32 v138, v138, v139
    v_mad_u32_u16 v216, v138, 2, v137
    ds_read_u16 v208, v208
    ds_read_u16 v209, v209
    ds_read_u16 v210, v210
    ds_read_u16 v211, v211
    ds_read_u16 v212, v212
    ds_read_u16 v213, v213
    ds_read_u16 v214, v214
    ds_read_u16 v215, v215
    ds_read_u16 v216, v216
    s_waitcnt vmcnt(2)
    buffer_load_dwordx4 v[52:55], v3, s[4:7], s72 offen offset:1024 sc1
    s_waitcnt vmcnt(2)
    buffer_load_dwordx4 v[56:59], v3, s[4:7], s72 offen offset:2048 sc1
    s_waitcnt vmcnt(2)
    buffer_load_dwordx4 v[60:63], v3, s[4:7], s72 offen offset:3072 sc1
    s_add_u32 s72, s72, 4096
    s_cmp_ge_u32 s72, s35
    s_cselect_b32 s36, 28672, 0
    s_sub_u32 s72, s72, s36
    s_waitcnt lgkmcnt(0)
    v_lshl_or_b32 v232, v209, 16, v208
    v_lshl_or_b32 v236, v210, 16, v209
    v_lshl_or_b32 v233, v211, 16, v210
    v_lshl_or_b32 v237, v212, 16, v211
    v_lshl_or_b32 v234, v213, 16, v212
    v_lshl_or_b32 v238, v214, 16, v213
    v_lshl_or_b32 v235, v215, 16, v214
    v_lshl_or_b32 v239, v216, 16, v215
    ds_write_b128 v128, v[232:235] offset:1024
    ds_write_b128 v128, v[236:239] offset:5184
    v_add_f32 v138, -1024.0, v136
    v_add_f32 v139, -1025.0, v136
    v_cvt_pk_bf16_f32 v138, v138, v139
    v_mad_u32_u16 v192, v138, 2, v137
    v_mad_u32_u16 v193, v138, 2, v137 op_sel:[1,0,0,0]
    v_add_f32 v138, -1026.0, v136
    v_add_f32 v139, -1027.0, v136
    v_cvt_pk_bf16_f32 v138, v138, v139
    v_mad_u32_u16 v194, v138, 2, v137
    v_mad_u32_u16 v195, v138, 2, v137 op_sel:[1,0,0,0]
    v_add_f32 v138, -1028.0, v136
    v_add_f32 v139, -1029.0, v136
    v_cvt_pk_bf16_f32 v138, v138, v139
    v_mad_u32_u16 v196, v138, 2, v137
    v_mad_u32_u16 v197, v138, 2, v137 op_sel:[1,0,0,0]
    v_add_f32 v138, -1030.0, v136
    v_add_f32 v139, -1031.0, v136
    v_cvt_pk_bf16_f32 v138, v138, v139
    v_mad_u32_u16 v198, v138, 2, v137
    v_mad_u32_u16 v199, v138, 2, v137 op_sel:[1,0,0,0]
    v_add_f32 v138, -1032.0, v136
    v_add_f32 v139, -1033.0, v136
    v_cvt_pk_bf16_f32 v138, v138, v139
    v_mad_u32_u16 v200, v138, 2, v137
    ds_read_u16 v192, v192
    ds_read_u16 v193, v193
    ds_read_u16 v194, v194
    ds_read_u16 v195, v195
    ds_read_u16 v196, v196
    ds_read_u16 v197, v197
    ds_read_u16 v198, v198
    ds_read_u16 v199, v199
    ds_read_u16 v200, v200
    s_waitcnt vmcnt(2)
    buffer_load_dwordx4 v[64:67], v3, s[4:7], s72 offen offset:0 sc1
    s_waitcnt vmcnt(2)
    buffer_load_dwordx4 v[68:71], v3, s[4:7], s72 offen offset:1024 sc1
    s_waitcnt vmcnt(2)
    buffer_load_dwordx4 v[72:75], v3, s[4:7], s72 offen offset:2048 sc1
    s_waitcnt lgkmcnt(0)
    v_lshl_or_b32 v224, v193, 16, v192
    v_lshl_or_b32 v228, v194, 16, v193
    v_lshl_or_b32 v225, v195, 16, v194
    v_lshl_or_b32 v229, v196, 16, v195
    v_lshl_or_b32 v226, v197, 16, v196
    v_lshl_or_b32 v230, v198, 16, v197
    v_lshl_or_b32 v227, v199, 16, v198
    v_lshl_or_b32 v231, v200, 16, v199
    ds_write_b128 v128, v[224:227] offset:2048
    ds_write_b128 v128, v[228:231] offset:6208
    v_add_f32 v138, -1536.0, v136
    v_add_f32 v139, -1537.0, v136
    v_cvt_pk_bf16_f32 v138, v138, v139
    v_mad_u32_u16 v208, v138, 2, v137
    v_mad_u32_u16 v209, v138, 2, v137 op_sel:[1,0,0,0]
    v_add_f32 v138, -1538.0, v136
    v_add_f32 v139, -1539.0, v136
    v_cvt_pk_bf16_f32 v138, v138, v139
    v_mad_u32_u16 v210, v138, 2, v137
    v_mad_u32_u16 v211, v138, 2, v137 op_sel:[1,0,0,0]
    v_add_f32 v138, -1540.0, v136
    v_add_f32 v139, -1541.0, v136
    v_cvt_pk_bf16_f32 v138, v138, v139
    v_mad_u32_u16 v212, v138, 2, v137
    v_mad_u32_u16 v213, v138, 2, v137 op_sel:[1,0,0,0]
    v_add_f32 v138, -1542.0, v136
    v_add_f32 v139, -1543.0, v136
    v_cvt_pk_bf16_f32 v138, v138, v139
    v_mad_u32_u16 v214, v138, 2, v137
    v_mad_u32_u16 v215, v138, 2, v137 op_sel:[1,0,0,0]
    v_add_f32 v138, -1544.0, v136
    v_add_f32 v139, -1545.0, v136
    v_cvt_pk_bf16_f32 v138, v138, v139
    v_mad_u32_u16 v216, v138, 2, v137
    s_add_u32 s71, s71, 30976
    s_mov_b32 exec_lo, 0
    v_lshl_add_u32 v208, v135, 1, s71
    s_sub_u32 s71, s71, 2
    v_lshl_add_u32 v209, v135, 1, s71
    s_sub_u32 s71, s71, 2
    v_lshl_add_u32 v210, v135, 1, s71
    s_sub_u32 s71, s71, 2
    v_lshl_add_u32 v211, v135, 1, s71
    s_sub_u32 s71, s71, 2
    v_lshl_add_u32 v212, v135, 1, s71
    s_sub_u32 s71, s71, 2
    v_lshl_add_u32 v213, v135, 1, s71
    s_sub_u32 s71, s71, 2
    v_lshl_add_u32 v214, v135, 1, s71
    s_sub_u32 s71, s71, 2
    v_lshl_add_u32 v215, v135, 1, s71
    s_sub_u32 s71, s71, 2
    v_lshl_add_u32 v216, v135, 1, s71
    s_sub_u32 s71, s71, 2
    s_mov_b32 exec_lo, -1
    s_nop 0
    ds_read_u16 v208, v208
    ds_read_u16 v209, v209
    ds_read_u16 v210, v210
    ds_read_u16 v211, v211
    ds_read_u16 v212, v212
    ds_read_u16 v213, v213
    ds_read_u16 v214, v214
    ds_read_u16 v215, v215
    ds_read_u16 v216, v216
    s_waitcnt vmcnt(2)
    buffer_load_dwordx4 v[76:79], v3, s[4:7], s72 offen offset:3072 sc1
    s_add_u32 s72, s72, 4096
    s_cmp_ge_u32 s72, s35
    s_cselect_b32 s36, 28672, 0
    s_sub_u32 s72, s72, s36
    s_waitcnt vmcnt(2)
    buffer_load_dwordx4 v[80:83], v3, s[4:7], s72 offen offset:0 sc1
    s_waitcnt vmcnt(2)
    buffer_load_dwordx4 v[84:87], v3, s[4:7], s72 offen offset:1024 sc1
    s_waitcnt lgkmcnt(0)
    v_cmp_ne_u32 vcc, 63, v1
    s_nop 1
    v_cndmask_b32_e64 v216, 0, v216, vcc
    v_lshl_or_b32 v232, v209, 16, v208
    v_lshl_or_b32 v236, v210, 16, v209
    v_lshl_or_b32 v233, v211, 16, v210
    v_lshl_or_b32 v237, v212, 16, v211
    v_lshl_or_b32 v234, v213, 16, v212
    v_lshl_or_b32 v238, v214, 16, v213
    v_lshl_or_b32 v235, v215, 16, v214
    v_lshl_or_b32 v239, v216, 16, v215
    ds_write_b128 v128, v[232:235] offset:3072
    ds_write_b128 v128, v[236:239] offset:7232
    s_mov_b64 exec, 3
    ds_write_b128 v128, v[140:143] offset:4096
    ds_write_b128 v128, v[140:143] offset:8256
    s_mov_b64 exec, -1
    s_waitcnt vmcnt(2)
    buffer_load_dwordx4 v[88:91], v3, s[4:7], s72 offen offset:2048 sc1
    s_waitcnt vmcnt(2)
    buffer_load_dwordx4 v[92:95], v3, s[4:7], s72 offen offset:3072 sc1
    s_add_u32 s72, s72, 4096
    s_cmp_ge_u32 s72, s35
    s_cselect_b32 s36, 28672, 0
    s_sub_u32 s72, s72, s36
    s_branch LYm
LYu:
    s_and_b32 s71, s3, 1
    s_lshl_b32 s71, s71, 12
    s_add_u32 s71, s71, 4096
    v_lshlrev_b32 v128, 5, v1
    v_add_u32 v129, 2048, v128
    buffer_load_dwordx2 v[130:131], v128, s[4:7], s71 offen sc1
    buffer_load_dwordx2 v[132:133], v129, s[4:7], s71 offen sc1
    v_lshrrev_b32 v134, 5, v1
    v_mul_u32_u24 v135, 28672, v134
    v_and_b32 v136, 31, v1
    v_lshl_add_u32 v135, v136, 4, v135
    v_mul_u32_u24 v134, 4608, v134
    v_lshl_add_u32 v134, v136, 4, v134
    v_add_u32 v134, 149504, v134
    v_mov_b32 v140, 0
    v_mov_b32 v141, 0
    v_mov_b32 v142, 0
    v_mov_b32 v143, 0
    s_mov_b32 exec_lo, 0x3fffffff
    s_mov_b32 exec_hi, 0x3fffffff
    ds_write_b128 v134, v[140:143]
    s_mov_b64 exec, -1
    s_waitcnt vmcnt(0)
    v_cmp_ne_u64 vcc, s[68:69], v[130:131]
    s_nop 0
    s_cbranch_vccz Lc26
    s_mov_b32 s77, 0
Lp27:
    buffer_load_dwordx2 v[130:131], v128, s[4:7], s71 offen sc1
    s_add_u32 s77, s77, 1
    s_waitcnt vmcnt(0)
    v_cmp_ne_u64 vcc, s[68:69], v[130:131]
    s_cmp_gt_u32 s77, 20000
    s_cbranch_scc1 Lo28
    s_cbranch_vccnz Lp27
Lo28:
Lc26:
    v_cmp_ne_u64 vcc, s[68:69], v[132:133]
    s_nop 0
    s_cbranch_vccz Lc29
    s_mov_b32 s77, 0
Lp30:
    buffer_load_dwordx2 v[132:133], v129, s[4:7], s71 offen sc1
    s_add_u32 s77, s77, 1
    s_waitcnt vmcnt(0)
    v_cmp_ne_u64 vcc, s[68:69], v[132:133]
    s_cmp_gt_u32 s77, 20000
    s_cbranch_scc1 Lo31
    s_cbranch_vccnz Lp30
Lo31:
Lc29:
    s_lshr_b32 s71, s15, 2
    s_lshl_b32 s71, s71, 9
    s_and_b32 s77, s15, 3
    s_lshl_b32 s77, s77, 2
    s_add_u32 s71, s71, s77
    s_and_b32 s77, s3, 1
    s_mul_i32 s77, s77, 917504
    s_add_u32 s71, s71, s77
    s_add_u32 s71, s71, 262144
    s_and_b32 s77, s3, 1
    s_lshl_b32 s77, s77, 11
    s_nop 0
    s_add_u32 s77, s77, 149984
    v_lshl_add_u32 v134, v1, 1, s77
    buffer_load_dword v144, v135, s[4:7], s71 offen sc1
    s_add_u32 s71, s71, 57344
    buffer_load_dword v145, v135, s[4:7], s71 offen sc1
    s_add_u32 s71, s71, 57344
    buffer_load_dword v146, v135, s[4:7], s71 offen sc1
    s_add_u32 s71, s71, 57344
    buffer_load_dword v147, v135, s[4:7], s71 offen sc1
    s_add_u32 s71, s71, 57344
    buffer_load_dword v148, v135, s[4:7], s71 offen sc1
    s_add_u32 s71, s71, 57344
    buffer_load_dword v149, v135, s[4:7], s71 offen sc1
    s_add_u32 s71, s71, 57344
    s_waitcnt vmcnt(5)
    s_nop 0
    ds_write_b16 v134, v144 offset:0
    ds_write_b16_d16_hi v134, v144 offset:4608
    buffer_load_dword v150, v135, s[4:7], s71 offen sc1
    s_add_u32 s71, s71, 57344
    s_waitcnt vmcnt(5)
    s_nop 0
    ds_write_b16 v134, v145 offset:128
    ds_write_b16_d16_hi v134, v145 offset:4736
    buffer_load_dword v151, v135, s[4:7], s71 offen sc1
    s_add_u32 s71, s71, 57344
    s_waitcnt vmcnt(5)
    s_nop 0
    ds_write_b16 v134, v146 offset:256
    ds_write_b16_d16_hi v134, v146 offset:4864
    buffer_load_dword v152, v135, s[4:7], s71 offen sc1
    s_add_u32 s71, s71, 57344
    s_waitcnt vmcnt(5)
    s_nop 0
    ds_write_b16 v134, v147 offset:384
    ds_write_b16_d16_hi v134, v147 offset:4992
    buffer_load_dword v153, v135, s[4:7], s71 offen sc1
    s_add_u32 s71, s71, 57344
    s_waitcnt vmcnt(5)
    s_nop 0
    ds_write_b16 v134, v148 offset:512
    ds_write_b16_d16_hi v134, v148 offset:5120
    buffer_load_dword v154, v135, s[4:7], s71 offen sc1
    s_add_u32 s71, s71, 57344
    s_waitcnt vmcnt(5)
    s_nop 0
    ds_write_b16 v134, v149 offset:640
    ds_write_b16_d16_hi v134, v149 offset:5248
    buffer_load_dword v155, v135, s[4:7], s71 offen sc1
    s_add_u32 s71, s71, 57344
    s_waitcnt vmcnt(5)
    s_nop 0
    ds_write_b16 v134, v150 offset:768
    ds_write_b16_d16_hi v134, v150 offset:5376
    buffer_load_dword v156, v135, s[4:7], s71 offen sc1
    s_add_u32 s71, s71, 57344
    s_waitcnt vmcnt(5)
    s_nop 0
    ds_write_b16 v134, v151 offset:896
    ds_write_b16_d16_hi v134, v151 offset:5504
    buffer_load_dword v157, v135, s[4:7], s71 offen sc1
    s_add_u32 s71, s71, 57344
    s_waitcnt vmcnt(5)
    s_nop 0
    ds_write_b16 v134, v152 offset:1024
    ds_write_b16_d16_hi v134, v152 offset:5632
    buffer_load_dword v158, v135, s[4:7], s71 offen sc1
    s_add_u32 s71, s71, 57344
    s_waitcnt vmcnt(5)
    s_nop 0
    ds_write_b16 v134, v153 offset:1152
    ds_write_b16_d16_hi v134, v153 offset:5760
    buffer_load_dword v159, v135, s[4:7], s71 offen sc1
    s_add_u32 s71, s71, 57344
    s_waitcnt vmcnt(5)
    ds_write_b16 v134, v154 offset:1280
    ds_write_b16_d16_hi v134, v154 offset:5888
    buffer_load_dwordx4 v[16:19], v3, s[4:7], s72 offen offset:0 sc1
    s_waitcnt vmcnt(5)
    ds_write_b16 v134, v155 offset:1408
    ds_write_b16_d16_hi v134, v155 offset:6016
    buffer_load_dwordx4 v[20:23], v3, s[4:7], s72 offen offset:1024 sc1
    s_waitcnt vmcnt(5)
    ds_write_b16 v134, v156 offset:1536
    ds_write_b16_d16_hi v134, v156 offset:6144
    buffer_load_dwordx4 v[24:27], v3, s[4:7], s72 offen offset:2048 sc1
    s_waitcnt vmcnt(5)
    ds_write_b16 v134, v157 offset:1664
    ds_write_b16_d16_hi v134, v157 offset:6272
    buffer_load_dwordx4 v[28:31], v3, s[4:7], s72 offen offset:3072 sc1
    s_add_u32 s72, s72, 4096
    s_cmp_ge_u32 s72, s35
    s_cselect_b32 s36, 28672, 0
    s_sub_u32 s72, s72, s36
    s_waitcnt vmcnt(5)
    ds_write_b16 v134, v158 offset:1792
    ds_write_b16_d16_hi v134, v158 offset:6400
    buffer_load_dwordx4 v[32:35], v3, s[4:7], s72 offen offset:0 sc1
    s_waitcnt vmcnt(5)
    ds_write_b16 v134, v159 offset:1920
    ds_write_b16_d16_hi v134, v159 offset:6528
    buffer_load_dwordx4 v[36:39], v3, s[4:7], s72 offen offset:1024 sc1
    s_waitcnt vmcnt(5)
    buffer_load_dwordx4 v[40:43], v3, s[4:7], s72 offen offset:2048 sc1
    s_waitcnt vmcnt(5)
    buffer_load_dwordx4 v[44:47], v3, s[4:7], s72 offen offset:3072 sc1
    s_add_u32 s72, s72, 4096
    s_cmp_ge_u32 s72, s35
    s_cselect_b32 s36, 28672, 0
    s_sub_u32 s72, s72, s36
    s_waitcnt vmcnt(5)
    buffer_load_dwordx4 v[48:51], v3, s[4:7], s72 offen offset:0 sc1
    s_waitcnt vmcnt(5)
    buffer_load_dwordx4 v[52:55], v3, s[4:7], s72 offen offset:1024 sc1
    s_waitcnt vmcnt(5)
    buffer_load_dwordx4 v[56:59], v3, s[4:7], s72 offen offset:2048 sc1
    s_waitcnt vmcnt(5)
    buffer_load_dwordx4 v[60:63], v3, s[4:7], s72 offen offset:3072 sc1
    s_add_u32 s72, s72, 4096
    s_cmp_ge_u32 s72, s35
    s_cselect_b32 s36, 28672, 0
    s_sub_u32 s72, s72, s36
    s_waitcnt vmcnt(5)
    buffer_load_dwordx4 v[64:67], v3, s[4:7], s72 offen offset:0 sc1
    s_waitcnt vmcnt(5)
    buffer_load_dwordx4 v[68:71], v3, s[4:7], s72 offen offset:1024 sc1
    s_waitcnt vmcnt(5)
    buffer_load_dwordx4 v[72:75], v3, s[4:7], s72 offen offset:2048 sc1
    s_waitcnt vmcnt(5)
    buffer_load_dwordx4 v[76:79], v3, s[4:7], s72 offen offset:3072 sc1
    s_add_u32 s72, s72, 4096
    s_cmp_ge_u32 s72, s35
    s_cselect_b32 s36, 28672, 0
    s_sub_u32 s72, s72, s36
    s_waitcnt vmcnt(5)
    buffer_load_dwordx4 v[80:83], v3, s[4:7], s72 offen offset:0 sc1
    s_waitcnt vmcnt(5)
    buffer_load_dwordx4 v[84:87], v3, s[4:7], s72 offen offset:1024 sc1
    s_waitcnt vmcnt(5)
    buffer_load_dwordx4 v[88:91], v3, s[4:7], s72 offen offset:2048 sc1
    s_waitcnt vmcnt(5)
    buffer_load_dwordx4 v[92:95], v3, s[4:7], s72 offen offset:3072 sc1
    s_add_u32 s72, s72, 4096
    s_cmp_ge_u32 s72, s35
    s_cselect_b32 s36, 28672, 0
    s_sub_u32 s72, s72, s36
LYm:
    s_waitcnt vmcnt(20)
    v_cmp_ne_u64 vcc, s[68:69], v[14:15]
    s_nop 0
    s_cbranch_vccz Lc32
    s_mov_b32 s77, 0
Lp33:
    buffer_load_dwordx2 v[14:15], v6, s[4:7], s74 offen sc1
    s_add_u32 s77, s77, 1
    s_waitcnt vmcnt(0)
    v_cmp_ne_u64 vcc, s[68:69], v[14:15]
    s_cmp_gt_u32 s77, 20000
    s_cbranch_scc1 Lo34
    s_cbranch_vccnz Lp33
Lo34:
Lc32:
    s_waitcnt lgkmcnt(0)
    s_nop 0
    ds_read_b64_tr_b16 v[192:193], v10 offset:0
    ds_read_b64_tr_b16 v[194:195], v10 offset:512
    ds_read_b64_tr_b16 v[196:197], v11 offset:0
    ds_read_b64_tr_b16 v[198:199], v11 offset:512
    ds_read_b64_tr_b16 v[200:201], v12 offset:0
    ds_read_b64_tr_b16 v[202:203], v12 offset:512
    ds_read_b64_tr_b16 v[204:205], v13 offset:0
    ds_read_b64_tr_b16 v[206:207], v13 offset:512
    ds_read_b64_tr_b16 v[208:209], v10 offset:2048
    ds_read_b64_tr_b16 v[210:211], v10 offset:2560
    ds_read_b64_tr_b16 v[212:213], v11 offset:2048
    ds_read_b64_tr_b16 v[214:215], v11 offset:2560
    ds_read_b64_tr_b16 v[216:217], v12 offset:2048
    ds_read_b64_tr_b16 v[218:219], v12 offset:2560
    ds_read_b64_tr_b16 v[220:221], v13 offset:2048
    ds_read_b64_tr_b16 v[222:223], v13 offset:2560
    s_setprio 2
    s_waitcnt vmcnt(19) lgkmcnt(14)
    v_mfma_f32_32x32x16_bf16 v[128:143], v[192:195], v[16:19], 0
    ds_read_b64_tr_b16 v[192:193], v10 offset:4096
    ds_read_b64_tr_b16 v[194:195], v10 offset:4608
    buffer_load_dwordx4 v[96:99], v3, s[4:7], s72 offen offset:0 sc1
    s_waitcnt lgkmcnt(14)
    v_mfma_f32_32x32x16_bf16 v[144:159], v[196:199], v[16:19], 0
    ds_read_b64_tr_b16 v[196:197], v11 offset:4096
    ds_read_b64_tr_b16 v[198:199], v11 offset:4608
    s_waitcnt lgkmcnt(14)
    v_mfma_f32_32x32x16_bf16 v[160:175], v[200:203], v[16:19], 0
    ds_read_b64_tr_b16 v[200:201], v12 offset:4096
    ds_read_b64_tr_b16 v[202:203], v12 offset:4608
    s_waitcnt lgkmcnt(14)
    v_mfma_f32_32x32x16_bf16 v[176:191], v[204:207], v[16:19], 0
    ds_read_b64_tr_b16 v[204:205], v13 offset:4096
    ds_read_b64_tr_b16 v[206:207], v13 offset:4608
    s_waitcnt vmcnt(19) lgkmcnt(14)
    v_mfma_f32_32x32x16_bf16 v[128:143], v[208:211], v[20:23], v[128:143]
    ds_read_b64_tr_b16 v[208:209], v10 offset:6144
    ds_read_b64_tr_b16 v[210:211], v10 offset:6656
    buffer_load_dwordx4 v[100:103], v3, s[4:7], s72 offen offset:1024 sc1
    s_waitcnt lgkmcnt(14)
    v_mfma_f32_32x32x16_bf16 v[144:159], v[212:215], v[20:23], v[144:159]
    ds_read_b64_tr_b16 v[212:213], v11 offset:6144
    ds_read_b64_tr_b16 v[214:215], v11 offset:6656
    s_waitcnt lgkmcnt(14)
    v_mfma_f32_32x32x16_bf16 v[160:175], v[216:219], v[20:23], v[160:175]
    ds_read_b64_tr_b16 v[216:217], v12 offset:6144
    ds_read_b64_tr_b16 v[218:219], v12 offset:6656
    s_waitcnt lgkmcnt(14)
    v_mfma_f32_32x32x16_bf16 v[176:191], v[220:223], v[20:23], v[176:191]
    ds_read_b64_tr_b16 v[220:221], v13 offset:6144
    ds_read_b64_tr_b16 v[222:223], v13 offset:6656
    s_waitcnt vmcnt(19) lgkmcnt(14)
    v_mfma_f32_32x32x16_bf16 v[128:143], v[192:195], v[24:27], v[128:143]
    ds_read_b64_tr_b16 v[192:193], v10 offset:8192
    ds_read_b64_tr_b16 v[194:195], v10 offset:8704
    buffer_load_dwordx4 v[104:107], v3, s[4:7], s72 offen offset:2048 sc1
    s_waitcnt lgkmcnt(14)
    v_mfma_f32_32x32x16_bf16 v[144:159], v[196:199], v[24:27], v[144:159]
    ds_read_b64_tr_b16 v[196:197], v11 offset:8192
    ds_read_b64_tr_b16 v[198:199], v11 offset:8704
    s_waitcnt lgkmcnt(14)
    v_mfma_f32_32x32x16_bf16 v[160:175], v[200:203], v[24:27], v[160:175]
    ds_read_b64_tr_b16 v[200:201], v12 offset:8192
    ds_read_b64_tr_b16 v[202:203], v12 offset:8704
    s_waitcnt lgkmcnt(14)
    v_mfma_f32_32x32x16_bf16 v[176:191], v[204:207], v[24:27], v[176:191]
    ds_read_b64_tr_b16 v[204:205], v13 offset:8192
    ds_read_b64_tr_b16 v[206:207], v13 offset:8704
    s_waitcnt vmcnt(19) lgkmcnt(14)
    v_mfma_f32_32x32x16_bf16 v[128:143], v[208:211], v[28:31], v[128:143]
    ds_read_b64_tr_b16 v[208:209], v10 offset:10240
    ds_read_b64_tr_b16 v[210:211], v10 offset:10752
    buffer_load_dwordx4 v[108:111], v3, s[4:7], s72 offen offset:3072 sc1
    s_add_u32 s72, s72, 4096
    s_cmp_ge_u32 s72, s35
    s_cselect_b32 s36, 28672, 0
    s_sub_u32 s72, s72, s36
    s_waitcnt lgkmcnt(14)
    v_mfma_f32_32x32x16_bf16 v[144:159], v[212:215], v[28:31], v[144:159]
    ds_read_b64_tr_b16 v[212:213], v11 offset:10240
    ds_read_b64_tr_b16 v[214:215], v11 offset:10752
    s_waitcnt lgkmcnt(14)
    v_mfma_f32_32x32x16_bf16 v[160:175], v[216:219], v[28:31], v[160:175]
    ds_read_b64_tr_b16 v[216:217], v12 offset:10240
    ds_read_b64_tr_b16 v[218:219], v12 offset:10752
    s_waitcnt lgkmcnt(14)
    v_mfma_f32_32x32x16_bf16 v[176:191], v[220:223], v[28:31], v[176:191]
    ds_read_b64_tr_b16 v[220:221], v13 offset:10240
    ds_read_b64_tr_b16 v[222:223], v13 offset:10752
    s_waitcnt vmcnt(19) lgkmcnt(14)
    v_mfma_f32_32x32x16_bf16 v[128:143], v[192:195], v[32:35], v[128:143]
    ds_read_b64_tr_b16 v[192:193], v10 offset:12288
    ds_read_b64_tr_b16 v[194:195], v10 offset:12800
    buffer_load_dwordx4 v[112:115], v3, s[4:7], s72 offen offset:0 sc1
    s_waitcnt lgkmcnt(14)
    v_mfma_f32_32x32x16_bf16 v[144:159], v[196:199], v[32:35], v[144:159]
    ds_read_b64_tr_b16 v[196:197], v11 offset:12288
    ds_read_b64_tr_b16 v[198:199], v11 offset:12800
    s_waitcnt lgkmcnt(14)
    v_mfma_f32_32x32x16_bf16 v[160:175], v[200:203], v[32:35], v[160:175]
    ds_read_b64_tr_b16 v[200:201], v12 offset:12288
    ds_read_b64_tr_b16 v[202:203], v12 offset:12800
    s_waitcnt lgkmcnt(14)
    v_mfma_f32_32x32x16_bf16 v[176:191], v[204:207], v[32:35], v[176:191]
    ds_read_b64_tr_b16 v[204:205], v13 offset:12288
    ds_read_b64_tr_b16 v[206:207], v13 offset:12800
    s_waitcnt vmcnt(19) lgkmcnt(14)
    v_mfma_f32_32x32x16_bf16 v[128:143], v[208:211], v[36:39], v[128:143]
    ds_read_b64_tr_b16 v[208:209], v10 offset:14336
    ds_read_b64_tr_b16 v[210:211], v10 offset:14848
    buffer_load_dwordx4 v[116:119], v3, s[4:7], s72 offen offset:1024 sc1
    s_waitcnt lgkmcnt(14)
    v_mfma_f32_32x32x16_bf16 v[144:159], v[212:215], v[36:39], v[144:159]
    ds_read_b64_tr_b16 v[212:213], v11 offset:14336
    ds_read_b64_tr_b16 v[214:215], v11 offset:14848
    s_waitcnt lgkmcnt(14)
    v_mfma_f32_32x32x16_bf16 v[160:175], v[216:219], v[36:39], v[160:175]
    ds_read_b64_tr_b16 v[216:217], v12 offset:14336
    ds_read_b64_tr_b16 v[218:219], v12 offset:14848
    s_waitcnt lgkmcnt(14)
    v_mfma_f32_32x32x16_bf16 v[176:191], v[220:223], v[36:39], v[176:191]
    ds_read_b64_tr_b16 v[220:221], v13 offset:14336
    ds_read_b64_tr_b16 v[222:223], v13 offset:14848
    s_waitcnt vmcnt(19) lgkmcnt(14)
    v_mfma_f32_32x32x16_bf16 v[128:143], v[192:195], v[40:43], v[128:143]
    ds_read_b64_tr_b16 v[192:193], v10 offset:16384
    ds_read_b64_tr_b16 v[194:195], v10 offset:16896
    buffer_load_dwordx4 v[120:123], v3, s[4:7], s72 offen offset:2048 sc1
    s_waitcnt lgkmcnt(14)
    v_mfma_f32_32x32x16_bf16 v[144:159], v[196:199], v[40:43], v[144:159]
    ds_read_b64_tr_b16 v[196:197], v11 offset:16384
    ds_read_b64_tr_b16 v[198:199], v11 offset:16896
    s_waitcnt lgkmcnt(14)
    v_mfma_f32_32x32x16_bf16 v[160:175], v[200:203], v[40:43], v[160:175]
    ds_read_b64_tr_b16 v[200:201], v12 offset:16384
    ds_read_b64_tr_b16 v[202:203], v12 offset:16896
    s_waitcnt lgkmcnt(14)
    v_mfma_f32_32x32x16_bf16 v[176:191], v[204:207], v[40:43], v[176:191]
    ds_read_b64_tr_b16 v[204:205], v13 offset:16384
    ds_read_b64_tr_b16 v[206:207], v13 offset:16896
    s_waitcnt vmcnt(19) lgkmcnt(14)
    v_mfma_f32_32x32x16_bf16 v[128:143], v[208:211], v[44:47], v[128:143]
    ds_read_b64_tr_b16 v[208:209], v10 offset:18432
    ds_read_b64_tr_b16 v[210:211], v10 offset:18944
    buffer_load_dwordx4 v[124:127], v3, s[4:7], s72 offen offset:3072 sc1
    s_barrier
    s_waitcnt lgkmcnt(14)
    v_mfma_f32_32x32x16_bf16 v[144:159], v[212:215], v[44:47], v[144:159]
    ds_read_b64_tr_b16 v[212:213], v11 offset:18432
    ds_read_b64_tr_b16 v[214:215], v11 offset:18944
    s_waitcnt lgkmcnt(14)
    v_mfma_f32_32x32x16_bf16 v[160:175], v[216:219], v[44:47], v[160:175]
    ds_read_b64_tr_b16 v[216:217], v12 offset:18432
    ds_read_b64_tr_b16 v[218:219], v12 offset:18944
    s_waitcnt lgkmcnt(14)
    v_mfma_f32_32x32x16_bf16 v[176:191], v[220:223], v[44:47], v[176:191]
    ds_read_b64_tr_b16 v[220:221], v13 offset:18432
    ds_read_b64_tr_b16 v[222:223], v13 offset:18944
    s_waitcnt vmcnt(19) lgkmcnt(14)
    s_nop 0
    v_mfma_f32_32x32x16_bf16 v[128:143], v[192:195], v[48:51], v[128:143]
    ds_read_b64_tr_b16 v[192:193], v10 offset:20480
    ds_read_b64_tr_b16 v[194:195], v10 offset:20992
    buffer_load_dwordx4 v[16:19], v3, s[4:7], s73 offen offset:0 sc1
    s_waitcnt lgkmcnt(14)
    s_nop 0
    v_mfma_f32_32x32x16_bf16 v[144:159], v[196:199], v[48:51], v[144:159]
    ds_read_b64_tr_b16 v[196:197], v11 offset:20480
    ds_read_b64_tr_b16 v[198:199], v11 offset:20992
    buffer_load_dwordx4 v[20:23], v3, s[4:7], s73 offen offset:1024 sc1
    s_add_u32 s73, s73, 2048
    s_cmp_ge_u32 s73, s37
    s_cselect_b32 s36, 14336, 0
    s_sub_u32 s73, s73, s36
    s_waitcnt lgkmcnt(14)
    s_nop 0
    v_mfma_f32_32x32x16_bf16 v[160:175], v[200:203], v[48:51], v[160:175]
    ds_read_b64_tr_b16 v[200:201], v12 offset:20480
    ds_read_b64_tr_b16 v[202:203], v12 offset:20992
    buffer_load_dwordx4 v[24:27], v3, s[4:7], s73 offen offset:0 sc1
    s_waitcnt lgkmcnt(14)
    s_nop 0
    v_mfma_f32_32x32x16_bf16 v[176:191], v[204:207], v[48:51], v[176:191]
    ds_read_b64_tr_b16 v[204:205], v13 offset:20480
    ds_read_b64_tr_b16 v[206:207], v13 offset:20992
    buffer_load_dwordx4 v[28:31], v3, s[4:7], s73 offen offset:1024 sc1
    s_add_u32 s73, s73, 2048
    s_cmp_ge_u32 s73, s37
    s_cselect_b32 s36, 14336, 0
    s_sub_u32 s73, s73, s36
    s_waitcnt vmcnt(22) lgkmcnt(14)
    s_nop 0
    v_mfma_f32_32x32x16_bf16 v[128:143], v[208:211], v[52:55], v[128:143]
    ds_read_b64_tr_b16 v[208:209], v10 offset:22528
    ds_read_b64_tr_b16 v[210:211], v10 offset:23040
    buffer_load_dwordx4 v[32:35], v3, s[4:7], s73 offen offset:0 sc1
    s_waitcnt lgkmcnt(14)
    s_nop 0
    v_mfma_f32_32x32x16_bf16 v[144:159], v[212:215], v[52:55], v[144:159]
    ds_read_b64_tr_b16 v[212:213], v11 offset:22528
    ds_read_b64_tr_b16 v[214:215], v11 offset:23040
    buffer_load_dwordx4 v[36:39], v3, s[4:7], s73 offen offset:1024 sc1
    s_add_u32 s73, s73, 2048
    s_cmp_ge_u32 s73, s37
    s_cselect_b32 s36, 14336, 0
    s_sub_u32 s73, s73, s36
    s_waitcnt lgkmcnt(14)
    s_nop 0
    v_mfma_f32_32x32x16_bf16 v[160:175], v[216:219], v[52:55], v[160:175]
    ds_read_b64_tr_b16 v[216:217], v12 offset:22528
    ds_read_b64_tr_b16 v[218:219], v12 offset:23040
    buffer_load_dwordx4 v[40:43], v3, s[4:7], s73 offen offset:0 sc1
    s_waitcnt lgkmcnt(14)
    s_nop 0
    v_mfma_f32_32x32x16_bf16 v[176:191], v[220:223], v[52:55], v[176:191]
    ds_read_b64_tr_b16 v[220:221], v13 offset:22528
    ds_read_b64_tr_b16 v[222:223], v13 offset:23040
    buffer_load_dwordx4 v[44:47], v3, s[4:7], s73 offen offset:1024 sc1
    s_add_u32 s73, s73, 2048
    s_cmp_ge_u32 s73, s37
    s_cselect_b32 s36, 14336, 0
    s_sub_u32 s73, s73, s36
    s_waitcnt vmcnt(25) lgkmcnt(14)
    s_nop 0
    v_mfma_f32_32x32x16_bf16 v[128:143], v[192:195], v[56:59], v[128:143]
    ds_read_b64_tr_b16 v[192:193], v10 offset:24576
    ds_read_b64_tr_b16 v[194:195], v10 offset:25088
    buffer_load_dwordx4 v[48:51], v3, s[4:7], s73 offen offset:0 sc1
    s_waitcnt lgkmcnt(14)
    s_nop 0
    v_mfma_f32_32x32x16_bf16 v[144:159], v[196:199], v[56:59], v[144:159]
    ds_read_b64_tr_b16 v[196:197], v12 offset:24576
    ds_read_b64_tr_b16 v[198:199], v12 offset:25088
    buffer_load_dwordx4 v[52:55], v3, s[4:7], s73 offen offset:1024 sc1
    s_add_u32 s73, s73, 2048
    s_cmp_ge_u32 s73, s37
    s_cselect_b32 s36, 14336, 0
    s_sub_u32 s73, s73, s36
    s_waitcnt lgkmcnt(14)
    v_mfma_f32_32x32x16_bf16 v[160:175], v[200:203], v[56:59], v[160:175]
    ds_read_b64_tr_b16 v[200:201], v10 offset:26624
    ds_read_b64_tr_b16 v[202:203], v10 offset:27136
    s_waitcnt lgkmcnt(14)
    v_mfma_f32_32x32x16_bf16 v[176:191], v[204:207], v[56:59], v[176:191]
    ds_read_b64_tr_b16 v[204:205], v12 offset:26624
    ds_read_b64_tr_b16 v[206:207], v12 offset:27136
    s_waitcnt vmcnt(26) lgkmcnt(14)
    s_nop 0
    v_mfma_f32_32x32x16_bf16 v[128:143], v[208:211], v[60:63], v[128:143]
    ds_read_b64_tr_b16 v[208:209], v10 offset:28672
    ds_read_b64_tr_b16 v[210:211], v10 offset:29184
    buffer_load_dwordx4 v[56:59], v3, s[4:7], s73 offen offset:0 sc1
    s_waitcnt lgkmcnt(14)
    v_mfma_f32_32x32x16_bf16 v[144:159], v[212:215], v[60:63], v[144:159]
    ds_read_b64_tr_b16 v[212:213], v12 offset:28672
    ds_read_b64_tr_b16 v[214:215], v12 offset:29184
    s_waitcnt lgkmcnt(14)
    v_mfma_f32_32x32x16_bf16 v[160:175], v[216:219], v[60:63], v[160:175]
    ds_read_b64_tr_b16 v[216:217], v10 offset:30720
    ds_read_b64_tr_b16 v[218:219], v10 offset:31232
    s_waitcnt lgkmcnt(14)
    v_mfma_f32_32x32x16_bf16 v[176:191], v[220:223], v[60:63], v[176:191]
    ds_read_b64_tr_b16 v[220:221], v12 offset:30720
    ds_read_b64_tr_b16 v[222:223], v12 offset:31232
    s_waitcnt vmcnt(26) lgkmcnt(14)
    v_mfma_f32_32x32x16_bf16 v[128:143], v[192:195], v[64:67], v[128:143]
    ds_read_b64_tr_b16 v[192:193], v10 offset:32768
    ds_read_b64_tr_b16 v[194:195], v10 offset:33280
    buffer_load_dwordx4 v[60:63], v3, s[4:7], s73 offen offset:1024 sc1
    s_add_u32 s73, s73, 2048
    s_cmp_ge_u32 s73, s37
    s_cselect_b32 s36, 14336, 0
    s_sub_u32 s73, s73, s36
    s_waitcnt lgkmcnt(14)
    v_mfma_f32_32x32x16_bf16 v[160:175], v[196:199], v[64:67], v[160:175]
    ds_read_b64_tr_b16 v[196:197], v12 offset:32768
    ds_read_b64_tr_b16 v[198:199], v12 offset:33280
    s_waitcnt vmcnt(26) lgkmcnt(14)
    v_mfma_f32_32x32x16_bf16 v[128:143], v[200:203], v[68:71], v[128:143]
    ds_read_b64_tr_b16 v[200:201], v10 offset:34816
    ds_read_b64_tr_b16 v[202:203], v10 offset:35328
    s_waitcnt lgkmcnt(14)
    v_mfma_f32_32x32x16_bf16 v[160:175], v[204:207], v[68:71], v[160:175]
    ds_read_b64_tr_b16 v[204:205], v12 offset:34816
    ds_read_b64_tr_b16 v[206:207], v12 offset:35328
    s_waitcnt vmcnt(25) lgkmcnt(14)
    v_mfma_f32_32x32x16_bf16 v[128:143], v[208:211], v[72:75], v[128:143]
    ds_read_b64_tr_b16 v[208:209], v10 offset:36864
    ds_read_b64_tr_b16 v[210:211], v10 offset:37376
    s_waitcnt lgkmcnt(14)
    v_mfma_f32_32x32x16_bf16 v[160:175], v[212:215], v[72:75], v[160:175]
    ds_read_b64_tr_b16 v[212:213], v12 offset:36864
    ds_read_b64_tr_b16 v[214:215], v12 offset:37376
    s_waitcnt vmcnt(24) lgkmcnt(14)
    v_mfma_f32_32x32x16_bf16 v[128:143], v[216:219], v[76:79], v[128:143]
    ds_read_b64_tr_b16 v[216:217], v10 offset:38912
    ds_read_b64_tr_b16 v[218:219], v10 offset:39424
    s_waitcnt lgkmcnt(14)
    v_mfma_f32_32x32x16_bf16 v[160:175], v[220:223], v[76:79], v[160:175]
    ds_read_b64_tr_b16 v[220:221], v12 offset:38912
    ds_read_b64_tr_b16 v[222:223], v12 offset:39424
    s_waitcnt vmcnt(23) lgkmcnt(14)
    v_mfma_f32_32x32x16_bf16 v[128:143], v[192:195], v[80:83], v[128:143]
    ds_read_b64_tr_b16 v[192:193], v10 offset:40960
    ds_read_b64_tr_b16 v[194:195], v10 offset:41472
    s_waitcnt lgkmcnt(14)
    v_mfma_f32_32x32x16_bf16 v[160:175], v[196:199], v[80:83], v[160:175]
    ds_read_b64_tr_b16 v[196:197], v12 offset:40960
    ds_read_b64_tr_b16 v[198:199], v12 offset:41472
    s_waitcnt vmcnt(22) lgkmcnt(14)
    v_mfma_f32_32x32x16_bf16 v[128:143], v[200:203], v[84:87], v[128:143]
    ds_read_b64_tr_b16 v[200:201], v10 offset:43008
    ds_read_b64_tr_b16 v[202:203], v10 offset:43520
    s_waitcnt lgkmcnt(14)
    v_mfma_f32_32x32x16_bf16 v[160:175], v[204:207], v[84:87], v[160:175]
    ds_read_b64_tr_b16 v[204:205], v12 offset:43008
    ds_read_b64_tr_b16 v[206:207], v12 offset:43520
    s_waitcnt vmcnt(21) lgkmcnt(14)
    v_mfma_f32_32x32x16_bf16 v[128:143], v[208:211], v[88:91], v[128:143]
    ds_read_b64_tr_b16 v[208:209], v10 offset:45056
    ds_read_b64_tr_b16 v[210:211], v10 offset:45568
    s_waitcnt lgkmcnt(14)
    v_mfma_f32_32x32x16_bf16 v[160:175], v[212:215], v[88:91], v[160:175]
    ds_read_b64_tr_b16 v[212:213], v12 offset:45056
    ds_read_b64_tr_b16 v[214:215], v12 offset:45568
    s_waitcnt vmcnt(20) lgkmcnt(14)
    v_mfma_f32_32x32x16_bf16 v[128:143], v[216:219], v[92:95], v[128:143]
    ds_read_b64_tr_b16 v[216:217], v10 offset:47104
    ds_read_b64_tr_b16 v[218:219], v10 offset:47616
    s_waitcnt lgkmcnt(14)
    v_mfma_f32_32x32x16_bf16 v[160:175], v[220:223], v[92:95], v[160:175]
    ds_read_b64_tr_b16 v[220:221], v12 offset:47104
    ds_read_b64_tr_b16 v[222:223], v12 offset:47616
    s_waitcnt vmcnt(19) lgkmcnt(14)
    v_mfma_f32_32x32x16_bf16 v[128:143], v[192:195], v[96:99], v[128:143]
    ds_read_b64_tr_b16 v[192:193], v10 offset:49152
    ds_read_b64_tr_b16 v[194:195], v10 offset:49664
    s_waitcnt lgkmcnt(14)
    v_mfma_f32_32x32x16_bf16 v[160:175], v[196:199], v[96:99], v[160:175]
    ds_read_b64_tr_b16 v[196:197], v12 offset:49152
    ds_read_b64_tr_b16 v[198:199], v12 offset:49664
    s_waitcnt vmcnt(18) lgkmcnt(14)
    v_mfma_f32_32x32x16_bf16 v[128:143], v[200:203], v[100:103], v[128:143]
    ds_read_b64_tr_b16 v[200:201], v10 offset:51200
    ds_read_b64_tr_b16 v[202:203], v10 offset:51712
    s_waitcnt lgkmcnt(14)
    v_mfma_f32_32x32x16_bf16 v[160:175], v[204:207], v[100:103], v[160:175]
    ds_read_b64_tr_b16 v[204:205], v12 offset:51200
    ds_read_b64_tr_b16 v[206:207], v12 offset:51712
    s_waitcnt vmcnt(17) lgkmcnt(14)
    v_mfma_f32_32x32x16_bf16 v[128:143], v[208:211], v[104:107], v[128:143]
    ds_read_b64_tr_b16 v[208:209], v10 offset:53248
    ds_read_b64_tr_b16 v[210:211], v10 offset:53760
    s_waitcnt lgkmcnt(14)
    v_mfma_f32_32x32x16_bf16 v[160:175], v[212:215], v[104:107], v[160:175]
    ds_read_b64_tr_b16 v[212:213], v12 offset:53248
    ds_read_b64_tr_b16 v[214:215], v12 offset:53760
    s_waitcnt vmcnt(16) lgkmcnt(14)
    v_mfma_f32_32x32x16_bf16 v[128:143], v[216:219], v[108:111], v[128:143]
    ds_read_b64_tr_b16 v[216:217], v10 offset:55296
    ds_read_b64_tr_b16 v[218:219], v10 offset:55808
    s_waitcnt lgkmcnt(14)
    v_mfma_f32_32x32x16_bf16 v[160:175], v[220:223], v[108:111], v[160:175]
    ds_read_b64_tr_b16 v[220:221], v12 offset:55296
    ds_read_b64_tr_b16 v[222:223], v12 offset:55808
    s_waitcnt vmcnt(15) lgkmcnt(14)
    v_mfma_f32_32x32x16_bf16 v[128:143], v[192:195], v[112:115], v[128:143]
    ds_read_b64_tr_b16 v[192:193], v11 offset:24576
    ds_read_b64_tr_b16 v[194:195], v11 offset:25088
    s_waitcnt lgkmcnt(14)
    v_mfma_f32_32x32x16_bf16 v[160:175], v[196:199], v[112:115], v[160:175]
    ds_read_b64_tr_b16 v[196:197], v13 offset:24576
    ds_read_b64_tr_b16 v[198:199], v13 offset:25088
    s_waitcnt vmcnt(14) lgkmcnt(14)
    v_mfma_f32_32x32x16_bf16 v[128:143], v[200:203], v[116:119], v[128:143]
    ds_read_b64_tr_b16 v[200:201], v11 offset:26624
    ds_read_b64_tr_b16 v[202:203], v11 offset:27136
    s_waitcnt lgkmcnt(14)
    v_mfma_f32_32x32x16_bf16 v[160:175], v[204:207], v[116:119], v[160:175]
    ds_read_b64_tr_b16 v[204:205], v13 offset:26624
    ds_read_b64_tr_b16 v[206:207], v13 offset:27136
    s_waitcnt vmcnt(13) lgkmcnt(14)
    v_mfma_f32_32x32x16_bf16 v[128:143], v[208:211], v[120:123], v[128:143]
    ds_read_b64_tr_b16 v[208:209], v11 offset:28672
    ds_read_b64_tr_b16 v[210:211], v11 offset:29184
    s_waitcnt lgkmcnt(14)
    v_mfma_f32_32x32x16_bf16 v[160:175], v[212:215], v[120:123], v[160:175]
    ds_read_b64_tr_b16 v[212:213], v13 offset:28672
    ds_read_b64_tr_b16 v[214:215], v13 offset:29184
    s_waitcnt vmcnt(12) lgkmcnt(14)
    v_mfma_f32_32x32x16_bf16 v[128:143], v[216:219], v[124:127], v[128:143]
    ds_read_b64_tr_b16 v[216:217], v11 offset:30720
    ds_read_b64_tr_b16 v[218:219], v11 offset:31232
    s_mul_i32 s72, s70, 114688
    s_lshl_b32 s71, s13, 12
    s_add_u32 s72, s72, s71
    s_add_u32 s72, s72, 6291456
    v_mov_b32 v9, 0xbfb8aa3b
    s_waitcnt lgkmcnt(14)
    v_mfma_f32_32x32x16_bf16 v[160:175], v[220:223], v[124:127], v[160:175]
    ds_read_b64_tr_b16 v[220:221], v13 offset:30720
    ds_read_b64_tr_b16 v[222:223], v13 offset:31232
    s_waitcnt lgkmcnt(14)
    v_mfma_f32_32x32x16_bf16 v[144:159], v[192:195], v[64:67], v[144:159]
    ds_read_b64_tr_b16 v[192:193], v11 offset:32768
    ds_read_b64_tr_b16 v[194:195], v11 offset:33280
    s_waitcnt lgkmcnt(14)
    v_mfma_f32_32x32x16_bf16 v[176:191], v[196:199], v[64:67], v[176:191]
    ds_read_b64_tr_b16 v[196:197], v13 offset:32768
    ds_read_b64_tr_b16 v[198:199], v13 offset:33280
    s_waitcnt lgkmcnt(14)
    v_mfma_f32_32x32x16_bf16 v[144:159], v[200:203], v[68:71], v[144:159]
    ds_read_b64_tr_b16 v[200:201], v11 offset:34816
    ds_read_b64_tr_b16 v[202:203], v11 offset:35328
    buffer_load_dwordx4 v[64:67], v3, s[4:7], s73 offen offset:0 sc1
    v_mul_f32 v128, v9, v128
    v_mul_f32 v129, v9, v129
    v_mul_f32 v130, v9, v130
    s_waitcnt lgkmcnt(14)
    v_mfma_f32_32x32x16_bf16 v[176:191], v[204:207], v[68:71], v[176:191]
    ds_read_b64_tr_b16 v[204:205], v13 offset:34816
    ds_read_b64_tr_b16 v[206:207], v13 offset:35328
    v_mul_f32 v131, v9, v131
    v_mul_f32 v132, v9, v132
    v_mul_f32 v133, v9, v133
    s_waitcnt lgkmcnt(14)
    v_mfma_f32_32x32x16_bf16 v[144:159], v[208:211], v[72:75], v[144:159]
    ds_read_b64_tr_b16 v[208:209], v11 offset:36864
    ds_read_b64_tr_b16 v[210:211], v11 offset:37376
    buffer_load_dwordx4 v[68:71], v3, s[4:7], s73 offen offset:1024 sc1
    s_add_u32 s73, s73, 2048
    s_cmp_ge_u32 s73, s37
    s_cselect_b32 s36, 14336, 0
    s_sub_u32 s73, s73, s36
    s_add_u32 s73, s73, 114688
    s_add_u32 s37, s37, 114688
    v_mul_f32 v134, v9, v134
    v_mul_f32 v135, v9, v135
    v_exp_f32 v128, v128
    s_waitcnt lgkmcnt(14)
    v_mfma_f32_32x32x16_bf16 v[176:191], v[212:215], v[72:75], v[176:191]
    ds_read_b64_tr_b16 v[212:213], v13 offset:36864
    ds_read_b64_tr_b16 v[214:215], v13 offset:37376
    v_mul_f32 v136, v9, v136
    v_exp_f32 v129, v129
    v_mul_f32 v137, v9, v137
    s_waitcnt lgkmcnt(14)
    v_mfma_f32_32x32x16_bf16 v[144:159], v[216:219], v[76:79], v[144:159]
    ds_read_b64_tr_b16 v[216:217], v11 offset:38912
    ds_read_b64_tr_b16 v[218:219], v11 offset:39424
    buffer_load_dwordx4 v[72:75], v3, s[4:7], s73 offen offset:0 sc1
    v_exp_f32 v130, v130
    v_mul_f32 v138, v9, v138
    v_exp_f32 v131, v131
    s_waitcnt lgkmcnt(14)
    v_mfma_f32_32x32x16_bf16 v[176:191], v[220:223], v[76:79], v[176:191]
    ds_read_b64_tr_b16 v[220:221], v13 offset:38912
    ds_read_b64_tr_b16 v[222:223], v13 offset:39424
    v_mul_f32 v139, v9, v139
    v_exp_f32 v132, v132
    v_mul_f32 v140, v9, v140
    s_waitcnt lgkmcnt(14)
    v_mfma_f32_32x32x16_bf16 v[144:159], v[192:195], v[80:83], v[144:159]
    ds_read_b64_tr_b16 v[192:193], v11 offset:40960
    ds_read_b64_tr_b16 v[194:195], v11 offset:41472
    buffer_load_dwordx4 v[76:79], v3, s[4:7], s73 offen offset:1024 sc1
    s_add_u32 s73, s73, 2048
    s_cmp_ge_u32 s73, s37
    s_cselect_b32 s36, 14336, 0
    s_sub_u32 s73, s73, s36
    v_exp_f32 v133, v133
    v_mul_f32 v141, v9, v141
    v_exp_f32 v134, v134
    s_waitcnt lgkmcnt(14)
    v_mfma_f32_32x32x16_bf16 v[176:191], v[196:199], v[80:83], v[176:191]
    ds_read_b64_tr_b16 v[196:197], v13 offset:40960
    ds_read_b64_tr_b16 v[198:199], v13 offset:41472
    v_mul_f32 v142, v9, v142
    v_exp_f32 v135, v135
    v_mul_f32 v143, v9, v143
    s_waitcnt lgkmcnt(14)
    v_mfma_f32_32x32x16_bf16 v[144:159], v[200:203], v[84:87], v[144:159]
    ds_read_b64_tr_b16 v[200:201], v11 offset:43008
    ds_read_b64_tr_b16 v[202:203], v11 offset:43520
    buffer_load_dwordx4 v[80:83], v3, s[4:7], s73 offen offset:0 sc1
    v_add_f32 v128, 1.0, v128
    v_exp_f32 v136, v136
    v_add_f32 v129, 1.0, v129
    s_waitcnt lgkmcnt(14)
    v_mfma_f32_32x32x16_bf16 v[176:191], v[204:207], v[84:87], v[176:191]
    ds_read_b64_tr_b16 v[204:205], v13 offset:43008
    ds_read_b64_tr_b16 v[206:207], v13 offset:43520
    v_exp_f32 v137, v137
    v_add_f32 v130, 1.0, v130
    v_exp_f32 v138, v138
    s_waitcnt lgkmcnt(14)
    v_mfma_f32_32x32x16_bf16 v[144:159], v[208:211], v[88:91], v[144:159]
    ds_read_b64_tr_b16 v[208:209], v11 offset:45056
    ds_read_b64_tr_b16 v[210:211], v11 offset:45568
    buffer_load_dwordx4 v[84:87], v3, s[4:7], s73 offen offset:1024 sc1
    s_add_u32 s73, s73, 2048
    s_cmp_ge_u32 s73, s37
    s_cselect_b32 s36, 14336, 0
    s_sub_u32 s73, s73, s36
    v_add_f32 v131, 1.0, v131
    v_exp_f32 v139, v139
    v_add_f32 v132, 1.0, v132
    s_waitcnt lgkmcnt(14)
    v_mfma_f32_32x32x16_bf16 v[176:191], v[212:215], v[88:91], v[176:191]
    ds_read_b64_tr_b16 v[212:213], v13 offset:45056
    ds_read_b64_tr_b16 v[214:215], v13 offset:45568
    v_exp_f32 v140, v140
    v_add_f32 v133, 1.0, v133
    v_exp_f32 v141, v141
    s_waitcnt lgkmcnt(14)
    v_mfma_f32_32x32x16_bf16 v[144:159], v[216:219], v[92:95], v[144:159]
    ds_read_b64_tr_b16 v[216:217], v11 offset:47104
    ds_read_b64_tr_b16 v[218:219], v11 offset:47616
    buffer_load_dwordx4 v[88:91], v3, s[4:7], s73 offen offset:0 sc1
    v_add_f32 v134, 1.0, v134
    v_exp_f32 v142, v142
    v_add_f32 v135, 1.0, v135
    s_waitcnt lgkmcnt(14)
    v_mfma_f32_32x32x16_bf16 v[176:191], v[220:223], v[92:95], v[176:191]
    ds_read_b64_tr_b16 v[220:221], v13 offset:47104
    ds_read_b64_tr_b16 v[222:223], v13 offset:47616
    v_exp_f32 v143, v143
    v_rcp_f32 v128, v128
    v_add_f32 v136, 1.0, v136
    s_waitcnt lgkmcnt(14)
    v_mfma_f32_32x32x16_bf16 v[144:159], v[192:195], v[96:99], v[144:159]
    ds_read_b64_tr_b16 v[192:193], v11 offset:49152
    ds_read_b64_tr_b16 v[194:195], v11 offset:49664
    buffer_load_dwordx4 v[92:95], v3, s[4:7], s73 offen offset:1024 sc1
    s_add_u32 s73, s73, 2048
    s_cmp_ge_u32 s73, s37
    s_cselect_b32 s36, 14336, 0
    s_sub_u32 s73, s73, s36
    v_rcp_f32 v129, v129
    v_add_f32 v137, 1.0, v137
    v_rcp_f32 v130, v130
    s_waitcnt lgkmcnt(14)
    v_mfma_f32_32x32x16_bf16 v[176:191], v[196:199], v[96:99], v[176:191]
    ds_read_b64_tr_b16 v[196:197], v13 offset:49152
    ds_read_b64_tr_b16 v[198:199], v13 offset:49664
    v_add_f32 v138, 1.0, v138
    v_rcp_f32 v131, v131
    v_add_f32 v139, 1.0, v139
    s_waitcnt lgkmcnt(14)
    v_mfma_f32_32x32x16_bf16 v[144:159], v[200:203], v[100:103], v[144:159]
    ds_read_b64_tr_b16 v[200:201], v11 offset:51200
    ds_read_b64_tr_b16 v[202:203], v11 offset:51712
    buffer_load_dwordx4 v[96:99], v3, s[4:7], s73 offen offset:0 sc1
    v_rcp_f32 v132, v132
    v_add_f32 v140, 1.0, v140
    v_rcp_f32 v133, v133
    s_waitcnt lgkmcnt(14)
    v_mfma_f32_32x32x16_bf16 v[176:191], v[204:207], v[100:103], v[176:191]
    ds_read_b64_tr_b16 v[204:205], v13 offset:51200
    ds_read_b64_tr_b16 v[206:207], v13 offset:51712
    v_add_f32 v141, 1.0, v141
    v_rcp_f32 v134, v134
    v_add_f32 v142, 1.0, v142
    s_waitcnt lgkmcnt(14)
    v_mfma_f32_32x32x16_bf16 v[144:159], v[208:211], v[104:107], v[144:159]
    ds_read_b64_tr_b16 v[208:209], v11 offset:53248
    ds_read_b64_tr_b16 v[210:211], v11 offset:53760
    buffer_load_dwordx4 v[100:103], v3, s[4:7], s73 offen offset:1024 sc1
    s_add_u32 s73, s73, 2048
    s_cmp_ge_u32 s73, s37
    s_cselect_b32 s36, 14336, 0
    s_sub_u32 s73, s73, s36
    v_rcp_f32 v135, v135
    v_add_f32 v143, 1.0, v143
    v_mul_f32 v128, v128, v160
    s_waitcnt lgkmcnt(14)
    v_mfma_f32_32x32x16_bf16 v[176:191], v[212:215], v[104:107], v[176:191]
    ds_read_b64_tr_b16 v[212:213], v13 offset:53248
    ds_read_b64_tr_b16 v[214:215], v13 offset:53760
    v_rcp_f32 v136, v136
    v_mul_f32 v129, v129, v161
    v_rcp_f32 v137, v137
    s_waitcnt lgkmcnt(14)
    v_mfma_f32_32x32x16_bf16 v[144:159], v[216:219], v[108:111], v[144:159]
    ds_read_b64_tr_b16 v[216:217], v11 offset:55296
    ds_read_b64_tr_b16 v[218:219], v11 offset:55808
    buffer_load_dwordx4 v[104:107], v3, s[4:7], s73 offen offset:0 sc1
    v_mul_f32 v130, v130, v162
    v_rcp_f32 v138, v138
    v_mul_f32 v131, v131, v163
    s_waitcnt lgkmcnt(14)
    v_mfma_f32_32x32x16_bf16 v[176:191], v[220:223], v[108:111], v[176:191]
    ds_read_b64_tr_b16 v[220:221], v13 offset:55296
    ds_read_b64_tr_b16 v[222:223], v13 offset:55808
    v_rcp_f32 v139, v139
    v_mul_f32 v132, v132, v164
    v_rcp_f32 v140, v140
    s_waitcnt lgkmcnt(14)
    v_mfma_f32_32x32x16_bf16 v[144:159], v[192:195], v[112:115], v[144:159]
    buffer_load_dwordx4 v[108:111], v3, s[4:7], s73 offen offset:1024 sc1
    s_add_u32 s73, s73, 2048
    s_cmp_ge_u32 s73, s37
    s_cselect_b32 s36, 14336, 0
    s_sub_u32 s73, s73, s36
    v_mul_f32 v133, v133, v165
    v_rcp_f32 v141, v141
    v_mul_f32 v134, v134, v166
    s_waitcnt lgkmcnt(12)
    v_mfma_f32_32x32x16_bf16 v[176:191], v[196:199], v[112:115], v[176:191]
    v_rcp_f32 v142, v142
    v_mul_f32 v135, v135, v167
    v_rcp_f32 v143, v143
    s_waitcnt lgkmcnt(10)
    v_mfma_f32_32x32x16_bf16 v[144:159], v[200:203], v[116:119], v[144:159]
    buffer_load_dwordx4 v[112:115], v3, s[4:7], s73 offen offset:0 sc1
    v_cvt_pk_bf16_f32 v128, v128, v129
    v_mul_f32 v136, v136, v168
    v_cvt_pk_bf16_f32 v129, v130, v131
    s_waitcnt lgkmcnt(8)
    v_mfma_f32_32x32x16_bf16 v[176:191], v[204:207], v[116:119], v[176:191]
    v_mul_f32 v137, v137, v169
    v_cvt_pk_bf16_f32 v130, v132, v133
    v_mul_f32 v138, v138, v170
    s_waitcnt lgkmcnt(6)
    v_mfma_f32_32x32x16_bf16 v[144:159], v[208:211], v[120:123], v[144:159]
    buffer_load_dwordx4 v[116:119], v3, s[4:7], s73 offen offset:1024 sc1
    s_add_u32 s73, s73, 2048
    s_cmp_ge_u32 s73, s37
    s_cselect_b32 s36, 14336, 0
    s_sub_u32 s73, s73, s36
    v_cvt_pk_bf16_f32 v131, v134, v135
    v_mul_f32 v139, v139, v171
    buffer_store_dwordx4 v[128:131], v3, s[4:7], s72 offen offset:0 sc1
    s_waitcnt lgkmcnt(4)
    v_mfma_f32_32x32x16_bf16 v[176:191], v[212:215], v[120:123], v[176:191]
    v_mul_f32 v140, v140, v172
    v_mul_f32 v141, v141, v173
    v_mul_f32 v142, v142, v174
    s_waitcnt lgkmcnt(2)
    v_mfma_f32_32x32x16_bf16 v[144:159], v[216:219], v[124:127], v[144:159]
    buffer_load_dwordx4 v[120:123], v3, s[4:7], s73 offen offset:0 sc1
    v_mul_f32 v143, v143, v175
    v_cvt_pk_bf16_f32 v136, v136, v137
    v_cvt_pk_bf16_f32 v137, v138, v139
    s_waitcnt lgkmcnt(0)
    s_nop 0
    v_mfma_f32_32x32x16_bf16 v[176:191], v[220:223], v[124:127], v[176:191]
    v_cvt_pk_bf16_f32 v138, v140, v141
    v_cvt_pk_bf16_f32 v139, v142, v143
    buffer_store_dwordx4 v[136:139], v3, s[4:7], s72 offen offset:1024 sc1
    s_setprio 2
    buffer_load_dwordx4 v[124:127], v3, s[4:7], s73 offen offset:1024 sc1
    s_lshr_b32 s71, s76, 2
    s_mul_i32 s74, s14, 56
    s_add_u32 s74, s74, s71
    s_lshl_b32 s74, s74, 5
    s_add_u32 s74, s74, 77824
    s_mul_i32 s73, s14, 229376
    s_lshl_b32 s71, s76, 10
    s_add_u32 s73, s73, s71
    s_add_u32 s73, s73, 6291456
    s_add_u32 s37, s73, 14336
    s_add_u32 s73, s73, s34
    buffer_load_dwordx2 v[4:5], v6, s[4:7], s74 offen sc1
    v_mul_f32 v144, v9, v144
    v_mul_f32 v145, v9, v145
    v_mul_f32 v146, v9, v146
    v_mul_f32 v147, v9, v147
    v_mul_f32 v148, v9, v148
    v_mul_f32 v149, v9, v149
    v_mul_f32 v150, v9, v150
    v_mul_f32 v151, v9, v151
    v_exp_f32 v144, v144
    v_mul_f32 v152, v9, v152
    v_exp_f32 v145, v145
    v_mul_f32 v153, v9, v153
    v_exp_f32 v146, v146
    v_mul_f32 v154, v9, v154
    v_exp_f32 v147, v147
    v_mul_f32 v155, v9, v155
    v_exp_f32 v148, v148
    v_mul_f32 v156, v9, v156
    v_exp_f32 v149, v149
    v_mul_f32 v157, v9, v157
    v_exp_f32 v150, v150
    v_mul_f32 v158, v9, v158
    v_exp_f32 v151, v151
    v_mul_f32 v159, v9, v159
    v_add_f32 v144, 1.0, v144
    v_exp_f32 v152, v152
    v_add_f32 v145, 1.0, v145
    v_exp_f32 v153, v153
    v_add_f32 v146, 1.0, v146
    v_exp_f32 v154, v154
    v_add_f32 v147, 1.0, v147
    v_exp_f32 v155, v155
    v_add_f32 v148, 1.0, v148
    v_exp_f32 v156, v156
    v_add_f32 v149, 1.0, v149
    v_exp_f32 v157, v157
    v_add_f32 v150, 1.0, v150
    v_exp_f32 v158, v158
    v_add_f32 v151, 1.0, v151
    v_exp_f32 v159, v159
    v_rcp_f32 v144, v144
    v_add_f32 v152, 1.0, v152
    v_rcp_f32 v145, v145
    v_add_f32 v153, 1.0, v153
    v_rcp_f32 v146, v146
    v_add_f32 v154, 1.0, v154
    v_rcp_f32 v147, v147
    v_add_f32 v155, 1.0, v155
    v_rcp_f32 v148, v148
    v_add_f32 v156, 1.0, v156
    v_rcp_f32 v149, v149
    v_add_f32 v157, 1.0, v157
    v_rcp_f32 v150, v150
    v_add_f32 v158, 1.0, v158
    v_rcp_f32 v151, v151
    v_add_f32 v159, 1.0, v159
    v_mul_f32 v144, v144, v176
    v_rcp_f32 v152, v152
    v_mul_f32 v145, v145, v177
    v_rcp_f32 v153, v153
    v_mul_f32 v146, v146, v178
    v_rcp_f32 v154, v154
    v_mul_f32 v147, v147, v179
    v_rcp_f32 v155, v155
    v_mul_f32 v148, v148, v180
    v_rcp_f32 v156, v156
    v_mul_f32 v149, v149, v181
    v_rcp_f32 v157, v157
    v_mul_f32 v150, v150, v182
    v_rcp_f32 v158, v158
    v_mul_f32 v151, v151, v183
    v_rcp_f32 v159, v159
    v_cvt_pk_bf16_f32 v144, v144, v145
    v_mul_f32 v152, v152, v184
    v_cvt_pk_bf16_f32 v145, v146, v147
    v_mul_f32 v153, v153, v185
    v_cvt_pk_bf16_f32 v146, v148, v149
    v_mul_f32 v154, v154, v186
    v_cvt_pk_bf16_f32 v147, v150, v151
    v_mul_f32 v155, v155, v187
    buffer_store_dwordx4 v[144:147], v3, s[4:7], s72 offen offset:2048 sc1
    v_mul_f32 v156, v156, v188
    v_mul_f32 v157, v157, v189
    v_mul_f32 v158, v158, v190
    v_mul_f32 v159, v159, v191
    v_cvt_pk_bf16_f32 v152, v152, v153
    v_cvt_pk_bf16_f32 v153, v154, v155
    v_cvt_pk_bf16_f32 v154, v156, v157
    v_cvt_pk_bf16_f32 v155, v158, v159
    buffer_store_dwordx4 v[152:155], v3, s[4:7], s72 offen offset:3072 sc1
    s_waitcnt vmcnt(2)
    v_cmp_ne_u64 vcc, s[68:69], v[4:5]
    s_mul_i32 s72, s70, 28
    s_add_u32 s72, s72, s13
    s_lshl_b32 s72, s72, 5
    s_add_u32 s72, s72, 77824
    s_cbranch_vccnz Lyslow
    buffer_load_dwordx4 v[224:227], v3, s[4:7], s73 offen offset:0 sc1
    buffer_load_dwordx4 v[228:231], v3, s[4:7], s73 offen offset:1024 sc1
    s_add_u32 s73, s73, 2048
    s_cmp_ge_u32 s73, s37
    s_cselect_b32 s36, 14336, 0
    s_sub_u32 s73, s73, s36
    buffer_load_dwordx4 v[232:235], v3, s[4:7], s73 offen offset:0 sc1
    buffer_load_dwordx4 v[236:239], v3, s[4:7], s73 offen offset:1024 sc1
    s_add_u32 s73, s73, 2048
    s_cmp_ge_u32 s73, s37
    s_cselect_b32 s36, 14336, 0
    s_sub_u32 s73, s73, s36
    s_waitcnt vmcnt(4)
    v_mov_b32 v14, s68
    v_mov_b32 v15, s69
    s_mov_b64 exec, 1
    buffer_store_dwordx2 v[14:15], off, s[4:7], s72 sc1
    s_mov_b64 exec, -1
    buffer_load_dwordx4 v[240:243], v3, s[4:7], s73 offen offset:0 sc1
    buffer_load_dwordx4 v[244:247], v3, s[4:7], s73 offen offset:1024 sc1
    s_add_u32 s73, s73, 2048
    s_cmp_ge_u32 s73, s37
    s_cselect_b32 s36, 14336, 0
    s_sub_u32 s73, s73, s36
    buffer_load_dwordx4 v[248:251], v3, s[4:7], s73 offen offset:0 sc1
    buffer_load_dwordx4 v[252:255], v3, s[4:7], s73 offen offset:1024 sc1
    s_add_u32 s73, s73, 2048
    s_cmp_ge_u32 s73, s37
    s_cselect_b32 s36, 14336, 0
    s_sub_u32 s73, s73, s36
    buffer_load_dwordx4 v[160:163], v3, s[4:7], s73 offen offset:0 sc1
    buffer_load_dwordx4 v[164:167], v3, s[4:7], s73 offen offset:1024 sc1
    s_add_u32 s73, s73, 2048
    s_cmp_ge_u32 s73, s37
    s_cselect_b32 s36, 14336, 0
    s_sub_u32 s73, s73, s36
    buffer_load_dwordx4 v[168:171], v3, s[4:7], s73 offen offset:0 sc1
    buffer_load_dwordx4 v[172:175], v3, s[4:7], s73 offen offset:1024 sc1
    s_add_u32 s73, s73, 2048
    s_cmp_ge_u32 s73, s37
    s_cselect_b32 s36, 14336, 0
    s_sub_u32 s73, s73, s36
    buffer_load_dwordx4 v[176:179], v3, s[4:7], s73 offen offset:0 sc1
    buffer_load_dwordx4 v[180:183], v3, s[4:7], s73 offen offset:1024 sc1
    s_add_u32 s73, s73, 2048
    s_cmp_ge_u32 s73, s37
    s_cselect_b32 s36, 14336, 0
    s_sub_u32 s73, s73, s36
    s_add_u32 s73, s73, 114688
    s_add_u32 s37, s37, 114688
    s_branch Lyj
Lyslow:
    s_waitcnt vmcnt(0)
    v_mov_b32 v14, s68
    v_mov_b32 v15, s69
    s_mov_b64 exec, 1
    buffer_store_dwordx2 v[14:15], off, s[4:7], s72 sc1
    s_mov_b64 exec, -1
    s_mov_b32 s77, 0
Lp35:
    buffer_load_dwordx2 v[4:5], v6, s[4:7], s74 offen sc1
    s_add_u32 s77, s77, 1
    s_waitcnt vmcnt(0)
    v_cmp_ne_u64 vcc, s[68:69], v[4:5]
    s_cmp_gt_u32 s77, 20000
    s_cbranch_scc1 Lo36
    s_cbranch_vccnz Lp35
Lo36:
    buffer_load_dwordx4 v[224:227], v3, s[4:7], s73 offen offset:0 sc1
    buffer_load_dwordx4 v[228:231], v3, s[4:7], s73 offen offset:1024 sc1
    s_add_u32 s73, s73, 2048
    s_cmp_ge_u32 s73, s37
    s_cselect_b32 s36, 14336, 0
    s_sub_u32 s73, s73, s36
    buffer_load_dwordx4 v[232:235], v3, s[4:7], s73 offen offset:0 sc1
    buffer_load_dwordx4 v[236:239], v3, s[4:7], s73 offen offset:1024 sc1
    s_add_u32 s73, s73, 2048
    s_cmp_ge_u32 s73, s37
    s_cselect_b32 s36, 14336, 0
    s_sub_u32 s73, s73, s36
    buffer_load_dwordx4 v[240:243], v3, s[4:7], s73 offen offset:0 sc1
    buffer_load_dwordx4 v[244:247], v3, s[4:7], s73 offen offset:1024 sc1
    s_add_u32 s73, s73, 2048
    s_cmp_ge_u32 s73, s37
    s_cselect_b32 s36, 14336, 0
    s_sub_u32 s73, s73, s36
    buffer_load_dwordx4 v[248:251], v3, s[4:7], s73 offen offset:0 sc1
    buffer_load_dwordx4 v[252:255], v3, s[4:7], s73 offen offset:1024 sc1
    s_add_u32 s73, s73, 2048
    s_cmp_ge_u32 s73, s37
    s_cselect_b32 s36, 14336, 0
    s_sub_u32 s73, s73, s36
    buffer_load_dwordx4 v[160:163], v3, s[4:7], s73 offen offset:0 sc1
    buffer_load_dwordx4 v[164:167], v3, s[4:7], s73 offen offset:1024 sc1
    s_add_u32 s73, s73, 2048
    s_cmp_ge_u32 s73, s37
    s_cselect_b32 s36, 14336, 0
    s_sub_u32 s73, s73, s36
    buffer_load_dwordx4 v[168:171], v3, s[4:7], s73 offen offset:0 sc1
    buffer_load_dwordx4 v[172:175], v3, s[4:7], s73 offen offset:1024 sc1
    s_add_u32 s73, s73, 2048
    s_cmp_ge_u32 s73, s37
    s_cselect_b32 s36, 14336, 0
    s_sub_u32 s73, s73, s36
    buffer_load_dwordx4 v[176:179], v3, s[4:7], s73 offen offset:0 sc1
    buffer_load_dwordx4 v[180:183], v3, s[4:7], s73 offen offset:1024 sc1
    s_add_u32 s73, s73, 2048
    s_cmp_ge_u32 s73, s37
    s_cselect_b32 s36, 14336, 0
    s_sub_u32 s73, s73, s36
    s_add_u32 s73, s73, 114688
    s_add_u32 s37, s37, 114688
Lyj:
    s_barrier
    s_setprio 0
Ljoin:
    s_mul_i32 s71, s3, 1280
    s_add_u32 s71, s71, 67584
    v_and_b32 v8, 3, v1
    v_mul_u32_u24 v8, 320, v8
    v_lshrrev_b32 v9, 2, v1
    v_lshl_add_u32 v8, v9, 4, v8
    v_add_u32 v8, s71, v8
    s_lshl_b32 s71, s3, 9
    s_add_u32 s71, s71, 149984
    v_lshl_add_u32 v10, v1, 3, s71
    s_lshl_b32 s71, s75, 16
    s_and_b32 s75, s75, 0xffff0000
    s_add_u32 s74, s74, 896
    s_lshl_b32 s70, s15, 13
    s_lshl_b32 s72, s3, 10
    s_add_u32 s70, s70, s72
    s_add_u32 s70, s70, 4194304
    s_waitcnt vmcnt(13)
    v_mfma_f32_32x32x16_bf16 v[128:143], v[16:19], v[224:227], 0
    v_mfma_f32_32x32x16_bf16 v[144:159], v[72:75], v[224:227], 0
    s_waitcnt vmcnt(12)
    v_mfma_f32_32x32x16_bf16 v[128:143], v[20:23], v[228:231], v[128:143]
    v_mfma_f32_32x32x16_bf16 v[144:159], v[76:79], v[228:231], v[144:159]
    s_waitcnt vmcnt(11)
    v_mfma_f32_32x32x16_bf16 v[128:143], v[24:27], v[232:235], v[128:143]
    v_mfma_f32_32x32x16_bf16 v[144:159], v[80:83], v[232:235], v[144:159]
    s_waitcnt vmcnt(10)
    v_mfma_f32_32x32x16_bf16 v[128:143], v[28:31], v[236:239], v[128:143]
    v_mfma_f32_32x32x16_bf16 v[144:159], v[84:87], v[236:239], v[144:159]
    s_waitcnt vmcnt(9)
    v_mfma_f32_32x32x16_bf16 v[128:143], v[32:35], v[240:243], v[128:143]
    v_mfma_f32_32x32x16_bf16 v[144:159], v[88:91], v[240:243], v[144:159]
    s_waitcnt vmcnt(8)
    v_mfma_f32_32x32x16_bf16 v[128:143], v[36:39], v[244:247], v[128:143]
    v_mfma_f32_32x32x16_bf16 v[144:159], v[92:95], v[244:247], v[144:159]
    s_waitcnt vmcnt(7)
    v_mfma_f32_32x32x16_bf16 v[128:143], v[40:43], v[248:251], v[128:143]
    v_mfma_f32_32x32x16_bf16 v[144:159], v[96:99], v[248:251], v[144:159]
    s_waitcnt vmcnt(6)
    v_mfma_f32_32x32x16_bf16 v[128:143], v[44:47], v[252:255], v[128:143]
    v_mfma_f32_32x32x16_bf16 v[144:159], v[100:103], v[252:255], v[144:159]
    s_waitcnt lgkmcnt(0)
    s_barrier
    s_nop 0
    ds_read_b128 v[184:187], v8 offset:0
    ds_read_b128 v[188:191], v8 offset:10240
    ds_read_b128 v[192:195], v8 offset:20480
    ds_read_b128 v[196:199], v8 offset:30720
    ds_read_b64 v[200:201], v10
    ds_read_b64 v[202:203], v10 offset:4608
    buffer_load_dwordx2 v[4:5], v6, s[4:7], s74 offen sc1
    s_waitcnt lgkmcnt(4)
    v_add_f32 v184, v184, v188
    v_add_f32 v185, v185, v189
    v_add_f32 v186, v186, v190
    v_add_f32 v187, v187, v191
    s_waitcnt lgkmcnt(2)
    v_add_f32 v192, v192, v196
    v_add_f32 v193, v193, v197
    v_add_f32 v194, v194, v198
    v_add_f32 v195, v195, v199
    s_waitcnt lgkmcnt(0)
    v_lshlrev_b32 v188, 16, v200
    v_and_b32 v189, 0xffff0000, v200
    v_lshlrev_b32 v190, 16, v201
    v_and_b32 v191, 0xffff0000, v201
    v_fmac_f32 v184, s71, v188
    v_fmac_f32 v185, s71, v189
    v_fmac_f32 v186, s71, v190
    v_fmac_f32 v187, s71, v191
    v_lshlrev_b32 v196, 16, v202
    v_and_b32 v197, 0xffff0000, v202
    v_lshlrev_b32 v198, 16, v203
    v_and_b32 v199, 0xffff0000, v203
    v_fmac_f32 v192, s75, v196
    v_fmac_f32 v193, s75, v197
    v_fmac_f32 v194, s75, v198
    v_fmac_f32_e64 v195, s75, v199
    v_cvt_pk_bf16_f32 v12, v184, v192
    v_cvt_pk_bf16_f32 v13, v185, v193
    v_cvt_pk_bf16_f32 v14, v186, v194
    v_cvt_pk_bf16_f32 v15, v187, v195
    buffer_store_dwordx4 v[12:15], v3, s[4:7], s70 offen sc1
    s_mul_i32 s72, s3, 224
    s_add_u32 s72, s72, s15
    s_lshl_b32 s72, s72, 5
    s_add_u32 s72, s72, 20480
    v_and_b32 v8, 15, v1
    v_lshrrev_b32 v9, 4, v1
    s_lshl_b32 s70, s3, 2
    v_add_u32 v9, s70, v9
    v_mul_u32_u24 v10, 896, v9
    v_lshl_add_u32 v10, v8, 3, v10
    s_mul_i32 s70, s14, 57344
    s_lshl_b32 s71, s11, 7
    s_add_u32 s70, s70, s71
    s_add_u32 s71, s70, 28672
    v_mul_u32_u24 v11, 528, v8
    v_lshl_add_u32 v11, v9, 4, v11
    v_and_b32 v2, 31, v1
    v_lshlrev_b32 v2, 4, v2
    v_lshrrev_b32_e64 v7, 5, v1
    v_mul_u32_u24 v7, 528, v7
    s_mul_i32 s75, s3, 8448
    v_add3_u32 v2, v2, v7, s75
    s_waitcnt vmcnt(1)
    v_cmp_ne_u64 vcc, s[68:69], v[4:5]
    s_nop 0
    s_cbranch_vccz Lc37
    s_mov_b32 s77, 0
Lp38:
    buffer_load_dwordx2 v[4:5], v6, s[4:7], s74 offen sc1
    s_add_u32 s77, s77, 1
    s_waitcnt vmcnt(0)
    v_cmp_ne_u64 vcc, s[68:69], v[4:5]
    s_cmp_gt_u32 s77, 20000
    s_cbranch_scc1 Lo39
    s_cbranch_vccnz Lp38
Lo39:
Lc37:
    buffer_load_dwordx4 v[184:187], v3, s[4:7], s73 offen offset:0 sc1
    buffer_load_dwordx4 v[188:191], v3, s[4:7], s73 offen offset:1024 sc1
    s_add_u32 s73, s73, 2048
    s_cmp_ge_u32 s73, s37
    s_cselect_b32 s36, 14336, 0
    s_sub_u32 s73, s73, s36
    buffer_load_dwordx4 v[192:195], v3, s[4:7], s73 offen offset:0 sc1
    buffer_load_dwordx4 v[196:199], v3, s[4:7], s73 offen offset:1024 sc1
    s_add_u32 s73, s73, 2048
    s_cmp_ge_u32 s73, s37
    s_cselect_b32 s36, 14336, 0
    s_sub_u32 s73, s73, s36
    s_waitcnt vmcnt(4)
    v_mov_b32 v4, s68
    v_mov_b32 v5, s69
    s_mov_b64 exec, 1
    buffer_store_dwordx2 v[4:5], off, s[4:7], s72 sc1
    s_mov_b64 exec, -1
    s_nop 0
    v_mfma_f32_32x32x16_bf16 v[128:143], v[48:51], v[160:163], v[128:143]
    v_mfma_f32_32x32x16_bf16 v[144:159], v[104:107], v[160:163], v[144:159]
    v_mfma_f32_32x32x16_bf16 v[128:143], v[52:55], v[164:167], v[128:143]
    v_mfma_f32_32x32x16_bf16 v[144:159], v[108:111], v[164:167], v[144:159]
    buffer_load_dwordx4 v[200:203], v3, s[4:7], s73 offen offset:0 sc1
    v_mfma_f32_32x32x16_bf16 v[128:143], v[56:59], v[168:171], v[128:143]
    v_mfma_f32_32x32x16_bf16 v[144:159], v[112:115], v[168:171], v[144:159]
    buffer_load_dwordx4 v[204:207], v3, s[4:7], s73 offen offset:1024 sc1
    s_add_u32 s73, s73, 2048
    s_cmp_ge_u32 s73, s37
    s_cselect_b32 s36, 14336, 0
    s_sub_u32 s73, s73, s36
    v_mfma_f32_32x32x16_bf16 v[128:143], v[60:63], v[172:175], v[128:143]
    v_mfma_f32_32x32x16_bf16 v[144:159], v[116:119], v[172:175], v[144:159]
    buffer_load_dwordx4 v[208:211], v3, s[4:7], s73 offen offset:0 sc1
    v_mfma_f32_32x32x16_bf16 v[128:143], v[64:67], v[176:179], v[128:143]
    v_mfma_f32_32x32x16_bf16 v[144:159], v[120:123], v[176:179], v[144:159]
    buffer_load_dwordx4 v[212:215], v3, s[4:7], s73 offen offset:1024 sc1
    s_add_u32 s73, s73, 2048
    s_cmp_ge_u32 s73, s37
    s_cselect_b32 s36, 14336, 0
    s_sub_u32 s73, s73, s36
    v_mfma_f32_32x32x16_bf16 v[128:143], v[68:71], v[180:183], v[128:143]
    v_mfma_f32_32x32x16_bf16 v[144:159], v[124:127], v[180:183], v[144:159]
    s_branch Lj3
Ljoin2:
    s_setprio 0
    ds_read_b128 v[128:131], v8 offset:0
    ds_read_b128 v[132:135], v8 offset:10240
    ds_read_b128 v[136:139], v8 offset:20480
    ds_read_b128 v[140:143], v8 offset:30720
    ds_read_b64 v[144:145], v10
    ds_read_b64 v[146:147], v10 offset:4608
    buffer_load_dwordx2 v[4:5], v6, s[4:7], s74 offen sc1
    s_waitcnt lgkmcnt(4)
    v_add_f32 v128, v128, v132
    v_add_f32 v129, v129, v133
    v_add_f32 v130, v130, v134
    v_add_f32 v131, v131, v135
    s_waitcnt lgkmcnt(2)
    v_add_f32 v136, v136, v140
    v_add_f32 v137, v137, v141
    v_add_f32 v138, v138, v142
    v_add_f32 v139, v139, v143
    s_waitcnt lgkmcnt(0)
    v_lshlrev_b32 v132, 16, v144
    v_and_b32 v133, 0xffff0000, v144
    v_lshlrev_b32 v134, 16, v145
    v_and_b32 v135, 0xffff0000, v145
    v_fmac_f32 v128, s71, v132
    v_fmac_f32 v129, s71, v133
    v_fmac_f32 v130, s71, v134
    v_fmac_f32 v131, s71, v135
    v_lshlrev_b32 v140, 16, v146
    v_and_b32 v141, 0xffff0000, v146
    v_lshlrev_b32 v142, 16, v147
    v_and_b32 v143, 0xffff0000, v147
    v_fmac_f32 v136, s75, v140
    v_fmac_f32 v137, s75, v141
    v_fmac_f32 v138, s75, v142
    v_fmac_f32_e64 v139, s75, v143
    v_cvt_pk_bf16_f32 v12, v128, v136
    v_cvt_pk_bf16_f32 v13, v129, v137
    v_cvt_pk_bf16_f32 v14, v130, v138
    v_cvt_pk_bf16_f32 v15, v131, v139
    buffer_store_dwordx4 v[12:15], v3, s[4:7], s70 offen sc1
    s_mul_i32 s72, s3, 224
    s_add_u32 s72, s72, s15
    s_lshl_b32 s72, s72, 5
    s_add_u32 s72, s72, 20480
    v_and_b32 v8, 15, v1
    v_lshrrev_b32 v9, 4, v1
    s_lshl_b32 s70, s3, 2
    v_add_u32 v9, s70, v9
    v_mul_u32_u24 v10, 896, v9
    v_lshl_add_u32 v10, v8, 3, v10
    s_mul_i32 s70, s14, 57344
    s_lshl_b32 s71, s11, 7
    s_add_u32 s70, s70, s71
    s_add_u32 s71, s70, 28672
    v_mul_u32_u24 v11, 528, v8
    v_lshl_add_u32 v11, v9, 4, v11
    v_and_b32 v2, 31, v1
    v_lshlrev_b32 v2, 4, v2
    v_lshrrev_b32_e64 v7, 5, v1
    v_mul_u32_u24 v7, 528, v7
    s_mul_i32 s75, s3, 8448
    v_add3_u32 v2, v2, v7, s75
    s_waitcnt vmcnt(15)
    v_mfma_f32_32x32x16_bf16 v[128:143], v[16:19], v[224:227], 0
    v_mfma_f32_32x32x16_bf16 v[144:159], v[72:75], v[224:227], 0
    s_waitcnt vmcnt(14)
    v_mfma_f32_32x32x16_bf16 v[128:143], v[20:23], v[228:231], v[128:143]
    v_mfma_f32_32x32x16_bf16 v[144:159], v[76:79], v[228:231], v[144:159]
    s_waitcnt vmcnt(1)
    v_cmp_ne_u64 vcc, s[68:69], v[4:5]
    s_nop 0
    s_cbranch_vccz Lc40
    s_mov_b32 s77, 0
Lp41:
    buffer_load_dwordx2 v[4:5], v6, s[4:7], s74 offen sc1
    s_add_u32 s77, s77, 1
    s_waitcnt vmcnt(0)
    v_cmp_ne_u64 vcc, s[68:69], v[4:5]
    s_cmp_gt_u32 s77, 20000
    s_cbranch_scc1 Lo42
    s_cbranch_vccnz Lp41
Lo42:
Lc40:
    buffer_load_dwordx4 v[184:187], v3, s[4:7], s73 offen offset:0 sc1
    buffer_load_dwordx4 v[188:191], v3, s[4:7], s73 offen offset:1024 sc1
    s_add_u32 s73, s73, 2048
    s_cmp_ge_u32 s73, s37
    s_cselect_b32 s36, 14336, 0
    s_sub_u32 s73, s73, s36
    buffer_load_dwordx4 v[192:195], v3, s[4:7], s73 offen offset:0 sc1
    buffer_load_dwordx4 v[196:199], v3, s[4:7], s73 offen offset:1024 sc1
    s_add_u32 s73, s73, 2048
    s_cmp_ge_u32 s73, s37
    s_cselect_b32 s36, 14336, 0
    s_sub_u32 s73, s73, s36
    v_mfma_f32_32x32x16_bf16 v[128:143], v[24:27], v[232:235], v[128:143]
    v_mfma_f32_32x32x16_bf16 v[144:159], v[80:83], v[232:235], v[144:159]
    v_mfma_f32_32x32x16_bf16 v[128:143], v[28:31], v[236:239], v[128:143]
    v_mfma_f32_32x32x16_bf16 v[144:159], v[84:87], v[236:239], v[144:159]
    v_mfma_f32_32x32x16_bf16 v[128:143], v[32:35], v[240:243], v[128:143]
    v_mfma_f32_32x32x16_bf16 v[144:159], v[88:91], v[240:243], v[144:159]
    v_mfma_f32_32x32x16_bf16 v[128:143], v[36:39], v[244:247], v[128:143]
    v_mfma_f32_32x32x16_bf16 v[144:159], v[92:95], v[244:247], v[144:159]
    v_mfma_f32_32x32x16_bf16 v[128:143], v[40:43], v[248:251], v[128:143]
    v_mfma_f32_32x32x16_bf16 v[144:159], v[96:99], v[248:251], v[144:159]
    s_waitcnt vmcnt(4)
    v_mov_b32 v4, s68
    v_mov_b32 v5, s69
    s_mov_b64 exec, 1
    buffer_store_dwordx2 v[4:5], off, s[4:7], s72 sc1
    s_mov_b64 exec, -1
    s_nop 0
    v_mfma_f32_32x32x16_bf16 v[128:143], v[44:47], v[252:255], v[128:143]
    v_mfma_f32_32x32x16_bf16 v[144:159], v[100:103], v[252:255], v[144:159]
    v_mfma_f32_32x32x16_bf16 v[128:143], v[48:51], v[160:163], v[128:143]
    v_mfma_f32_32x32x16_bf16 v[144:159], v[104:107], v[160:163], v[144:159]
    v_mfma_f32_32x32x16_bf16 v[128:143], v[52:55], v[164:167], v[128:143]
    v_mfma_f32_32x32x16_bf16 v[144:159], v[108:111], v[164:167], v[144:159]
    buffer_load_dwordx4 v[200:203], v3, s[4:7], s73 offen offset:0 sc1
    v_mfma_f32_32x32x16_bf16 v[128:143], v[56:59], v[168:171], v[128:143]
    v_mfma_f32_32x32x16_bf16 v[144:159], v[112:115], v[168:171], v[144:159]
    buffer_load_dwordx4 v[204:207], v3, s[4:7], s73 offen offset:1024 sc1
    s_add_u32 s73, s73, 2048
    s_cmp_ge_u32 s73, s37
    s_cselect_b32 s36, 14336, 0
    s_sub_u32 s73, s73, s36
    v_mfma_f32_32x32x16_bf16 v[128:143], v[60:63], v[172:175], v[128:143]
    v_mfma_f32_32x32x16_bf16 v[144:159], v[116:119], v[172:175], v[144:159]
    buffer_load_dwordx4 v[208:211], v3, s[4:7], s73 offen offset:0 sc1
    v_mfma_f32_32x32x16_bf16 v[128:143], v[64:67], v[176:179], v[128:143]
    v_mfma_f32_32x32x16_bf16 v[144:159], v[120:123], v[176:179], v[144:159]
    buffer_load_dwordx4 v[212:215], v3, s[4:7], s73 offen offset:1024 sc1
    s_add_u32 s73, s73, 2048
    s_cmp_ge_u32 s73, s37
    s_cselect_b32 s36, 14336, 0
    s_sub_u32 s73, s73, s36
    v_mfma_f32_32x32x16_bf16 v[128:143], v[68:71], v[180:183], v[128:143]
    v_mfma_f32_32x32x16_bf16 v[144:159], v[124:127], v[180:183], v[144:159]
Lj3:
    s_nop 10
    s_nop 0
    ds_write_b128 v2, v[128:131] offset:0
    ds_write_b128 v2, v[132:135] offset:1056
    ds_write_b128 v2, v[136:139] offset:2112
    ds_write_b128 v2, v[140:143] offset:3168
    ds_write_b128 v2, v[144:147] offset:4224
    ds_write_b128 v2, v[148:151] offset:5280
    ds_write_b128 v2, v[152:155] offset:6336
    ds_write_b128 v2, v[156:159] offset:7392
    s_lshr_b32 s72, s14, 2
    s_mul_i32 s72, s72, 224
    s_lshl_b32 s38, s11, 5
    s_lshl_b32 s74, s3, 2
    s_add_u32 s38, s38, s74
    s_add_u32 s72, s72, s38
    s_lshl_b32 s72, s72, 5
    s_add_u32 s72, s72, 20480
    s_lshl_b32 s38, s38, 13
    s_lshl_b32 s74, s14, 8
    s_add_u32 s38, s38, s74
    s_add_u32 s38, s38, 4194304
    v_add_u32 v2, 67584, v2
    s_mov_b32 s75, 0xbfb8aa3b
    s_waitcnt vmcnt(8)
    v_mfma_f32_32x32x16_bf16 v[240:255], v[16:19], v[184:187], 0
    v_mfma_f32_32x32x16_bf16 v[160:175], v[72:75], v[184:187], 0
    buffer_load_dwordx4 v[216:219], v3, s[4:7], s73 offen offset:0 sc1
    buffer_load_dwordx4 v[220:223], v3, s[4:7], s73 offen offset:1024 sc1
    s_add_u32 s73, s73, 2048
    s_cmp_ge_u32 s73, s37
    s_cselect_b32 s36, 14336, 0
    s_sub_u32 s73, s73, s36
    s_waitcnt vmcnt(9)
    s_nop 0
    v_mfma_f32_32x32x16_bf16 v[240:255], v[20:23], v[188:191], v[240:255]
    v_mfma_f32_32x32x16_bf16 v[160:175], v[76:79], v[188:191], v[160:175]
    buffer_load_dwordx4 v[224:227], v3, s[4:7], s73 offen offset:0 sc1
    buffer_load_dwordx4 v[228:231], v3, s[4:7], s73 offen offset:1024 sc1
    s_add_u32 s73, s73, 2048
    s_cmp_ge_u32 s73, s37
    s_cselect_b32 s36, 14336, 0
    s_sub_u32 s73, s73, s36
    s_waitcnt lgkmcnt(0)
    s_barrier
    ds_read_b128 v[128:131], v11 offset:0
    ds_read_b128 v[132:135], v11 offset:8448
    ds_read_b128 v[136:139], v11 offset:16896
    ds_read_b128 v[140:143], v11 offset:25344
    ds_read_b128 v[144:147], v11 offset:33792
    ds_read_b128 v[148:151], v11 offset:42240
    ds_read_b128 v[152:155], v11 offset:50688
    ds_read_b128 v[156:159], v11 offset:59136
    s_waitcnt vmcnt(10)
    s_nop 0
    v_mfma_f32_32x32x16_bf16 v[240:255], v[24:27], v[192:195], v[240:255]
    v_mfma_f32_32x32x16_bf16 v[160:175], v[80:83], v[192:195], v[160:175]
    buffer_load_dwordx4 v[232:235], v3, s[4:7], s73 offen offset:0 sc1
    buffer_load_dwordx4 v[236:239], v3, s[4:7], s73 offen offset:1024 sc1
    buffer_load_dwordx2 v[4:5], v6, s[4:7], s72 offen sc1
    buffer_load_dwordx2 v[12:13], v10, s[48:51], s70 offen
    buffer_load_dwordx2 v[14:15], v10, s[48:51], s71 offen
    s_waitcnt vmcnt(14)
    v_mfma_f32_32x32x16_bf16 v[240:255], v[28:31], v[196:199], v[240:255]
    v_mfma_f32_32x32x16_bf16 v[160:175], v[84:87], v[196:199], v[160:175]
    s_waitcnt lgkmcnt(6)
    v_add_f32 v128, v128, v132
    v_add_f32 v129, v129, v133
    v_add_f32 v130, v130, v134
    v_add_f32 v131, v131, v135
    s_waitcnt lgkmcnt(4)
    v_add_f32 v136, v136, v140
    v_add_f32 v137, v137, v141
    v_add_f32 v138, v138, v142
    v_add_f32 v139, v139, v143
    s_waitcnt lgkmcnt(2)
    v_add_f32 v144, v144, v148
    v_add_f32 v145, v145, v149
    v_add_f32 v146, v146, v150
    v_add_f32 v147, v147, v151
    s_waitcnt lgkmcnt(0)
    v_add_f32 v152, v152, v156
    v_add_f32 v153, v153, v157
    v_add_f32 v154, v154, v158
    v_add_f32 v155, v155, v159
    v_add_f32 v128, v128, v136
    v_add_f32 v129, v129, v137
    v_add_f32 v130, v130, v138
    v_add_f32 v131, v131, v139
    v_add_f32 v144, v144, v152
    v_add_f32 v145, v145, v153
    v_add_f32 v146, v146, v154
    v_add_f32 v147, v147, v155
    v_add_f32 v128, v128, v144
    v_add_f32 v129, v129, v145
    v_add_f32 v130, v130, v146
    v_add_f32 v131, v131, v147
    v_mul_f32 v132, s75, v128
    v_mul_f32 v133, s75, v129
    v_mul_f32 v134, s75, v130
    v_mul_f32 v135, s75, v131
    v_exp_f32 v132, v132
    v_exp_f32 v133, v133
    v_exp_f32 v134, v134
    v_exp_f32 v135, v135
    v_add_f32 v132, 1.0, v132
    v_add_f32 v133, 1.0, v133
    v_add_f32 v134, 1.0, v134
    v_add_f32 v135, 1.0, v135
    v_rcp_f32 v132, v132
    v_rcp_f32 v133, v133
    v_rcp_f32 v134, v134
    v_rcp_f32 v135, v135
    v_mul_f32 v128, v128, v132
    v_mul_f32 v129, v129, v133
    v_mul_f32 v130, v130, v134
    v_mul_f32 v131, v131, v135
    v_lshrrev_b32 v136, 4, v1
    v_lshlrev_b32_e64 v137, 4, v8
    v_lshl_add_u32 v138, v136, 13, v137
    v_mul_u32_u24 v139, 272, v9
    v_add3_u32 v139, v139, v137, 0
    v_add_u32 v139, 136192, v139
    v_mul_u32_u24 v140, 544, v8
    v_lshl_add_u32 v140, v9, 2, v140
    v_add_u32 v140, 136192, v140
    v_add_u32 v11, 67584, v11
    s_waitcnt vmcnt(12)
    v_mfma_f32_32x32x16_bf16 v[240:255], v[32:35], v[200:203], v[240:255]
    v_mfma_f32_32x32x16_bf16 v[160:175], v[88:91], v[200:203], v[160:175]
    s_waitcnt vmcnt(11)
    v_mfma_f32_32x32x16_bf16 v[240:255], v[36:39], v[204:207], v[240:255]
    v_mfma_f32_32x32x16_bf16 v[160:175], v[92:95], v[204:207], v[160:175]
    s_waitcnt vmcnt(10)
    v_mfma_f32_32x32x16_bf16 v[240:255], v[40:43], v[208:211], v[240:255]
    v_mfma_f32_32x32x16_bf16 v[160:175], v[96:99], v[208:211], v[160:175]
    s_waitcnt vmcnt(9)
    v_mfma_f32_32x32x16_bf16 v[240:255], v[44:47], v[212:215], v[240:255]
    v_mfma_f32_32x32x16_bf16 v[160:175], v[100:103], v[212:215], v[160:175]
    s_waitcnt vmcnt(8)
    v_mfma_f32_32x32x16_bf16 v[240:255], v[48:51], v[216:219], v[240:255]
    v_mfma_f32_32x32x16_bf16 v[160:175], v[104:107], v[216:219], v[160:175]
    s_waitcnt vmcnt(7)
    v_mfma_f32_32x32x16_bf16 v[240:255], v[52:55], v[220:223], v[240:255]
    v_mfma_f32_32x32x16_bf16 v[160:175], v[108:111], v[220:223], v[160:175]
    s_waitcnt vmcnt(2)
    v_cmp_ne_u64 vcc, s[68:69], v[4:5]
    s_nop 0
    s_cbranch_vccz Lc43
    s_mov_b32 s77, 0
Lp44:
    buffer_load_dwordx2 v[4:5], v6, s[4:7], s72 offen sc1
    s_add_u32 s77, s77, 1
    s_waitcnt vmcnt(0)
    v_cmp_ne_u64 vcc, s[68:69], v[4:5]
    s_cmp_gt_u32 s77, 20000
    s_cbranch_scc1 Lo45
    s_cbranch_vccnz Lp44
Lo45:
Lc43:
    buffer_load_dwordx4 v[144:147], v138, s[4:7], s38 offen sc1
    v_mfma_f32_32x32x16_bf16 v[240:255], v[56:59], v[224:227], v[240:255]
    v_mfma_f32_32x32x16_bf16 v[160:175], v[112:115], v[224:227], v[160:175]
    v_mfma_f32_32x32x16_bf16 v[240:255], v[60:63], v[228:231], v[240:255]
    v_mfma_f32_32x32x16_bf16 v[160:175], v[116:119], v[228:231], v[160:175]
    v_mfma_f32_32x32x16_bf16 v[240:255], v[64:67], v[232:235], v[240:255]
    v_mfma_f32_32x32x16_bf16 v[160:175], v[120:123], v[232:235], v[160:175]
    v_mfma_f32_32x32x16_bf16 v[240:255], v[68:71], v[236:239], v[240:255]
    v_mfma_f32_32x32x16_bf16 v[160:175], v[124:127], v[236:239], v[160:175]
    s_nop 10
    s_nop 0
    ds_write_b128 v2, v[240:243] offset:0
    ds_write_b128 v2, v[244:247] offset:1056
    ds_write_b128 v2, v[248:251] offset:2112
    ds_write_b128 v2, v[252:255] offset:3168
    ds_write_b128 v2, v[160:163] offset:4224
    ds_write_b128 v2, v[164:167] offset:5280
    ds_write_b128 v2, v[168:171] offset:6336
    ds_write_b128 v2, v[172:175] offset:7392
    s_waitcnt vmcnt(0)
    ds_write_b128 v139, v[144:147]
    s_waitcnt lgkmcnt(0)
    s_barrier
    s_nop 0
    ds_read2_b32 v[148:149], v140 offset0:0 offset1:68
    ds_read_b128 v[16:19], v11 offset:0
    ds_read_b128 v[20:23], v11 offset:8448
    ds_read_b128 v[24:27], v11 offset:16896
    ds_read_b128 v[28:31], v11 offset:25344
    ds_read_b128 v[32:35], v11 offset:33792
    ds_read_b128 v[36:39], v11 offset:42240
    ds_read_b128 v[40:43], v11 offset:50688
    ds_read_b128 v[44:47], v11 offset:59136
    ds_read2_b32 v[150:151], v140 offset0:32 offset1:100
    s_waitcnt lgkmcnt(9)
    v_lshlrev_b32 v136, 16, v148
    v_lshlrev_b32_e64 v140, 16, v12
    v_and_b32 v137, 0xffff0000, v148
    v_and_b32 v141, 0xffff0000, v12
    v_lshlrev_b32 v138, 16, v149
    v_lshlrev_b32 v142, 16, v13
    v_and_b32 v139, 0xffff0000, v149
    v_and_b32 v143, 0xffff0000, v13
    v_fmac_f32 v140, v128, v136
    v_fmac_f32 v141, v129, v137
    v_fmac_f32 v142, v130, v138
    v_fmac_f32 v143, v131, v139
    v_cvt_pk_bf16_f32 v144, v140, v141
    v_cvt_pk_bf16_f32 v145, v142, v143
    buffer_store_dwordx2 v[144:145], v10, s[64:67], s70 offen sc0 sc1 nt
    s_waitcnt lgkmcnt(7)
    v_add_f32 v16, v16, v20
    v_add_f32 v17, v17, v21
    v_add_f32 v18, v18, v22
    v_add_f32 v19, v19, v23
    s_waitcnt lgkmcnt(5)
    v_add_f32 v24, v24, v28
    v_add_f32 v25, v25, v29
    v_add_f32 v26, v26, v30
    v_add_f32 v27, v27, v31
    s_waitcnt lgkmcnt(3)
    v_add_f32 v32, v32, v36
    v_add_f32 v33, v33, v37
    v_add_f32 v34, v34, v38
    v_add_f32 v35, v35, v39
    s_waitcnt lgkmcnt(1)
    v_add_f32 v40, v40, v44
    v_add_f32 v41, v41, v45
    v_add_f32 v42, v42, v46
    v_add_f32 v43, v43, v47
    v_add_f32 v16, v16, v24
    v_add_f32 v17, v17, v25
    v_add_f32 v18, v18, v26
    v_add_f32 v19, v19, v27
    v_add_f32 v32, v32, v40
    v_add_f32 v33, v33, v41
    v_add_f32 v34, v34, v42
    v_add_f32 v35, v35, v43
    v_add_f32 v16, v16, v32
    v_add_f32 v17, v17, v33
    v_add_f32 v18, v18, v34
    v_add_f32 v19, v19, v35
    v_mul_f32 v20, s75, v16
    v_mul_f32 v21, s75, v17
    v_mul_f32 v22, s75, v18
    v_mul_f32 v23, s75, v19
    v_exp_f32 v20, v20
    v_exp_f32 v21, v21
    v_exp_f32 v22, v22
    v_exp_f32 v23, v23
    v_add_f32 v20, 1.0, v20
    v_add_f32 v21, 1.0, v21
    v_add_f32 v22, 1.0, v22
    v_add_f32 v23, 1.0, v23
    v_rcp_f32 v20, v20
    v_rcp_f32 v21, v21
    v_rcp_f32 v22, v22
    v_rcp_f32 v23, v23
    v_mul_f32 v16, v16, v20
    v_mul_f32 v17, v17, v21
    v_mul_f32 v18, v18, v22
    v_mul_f32 v19, v19, v23
    s_waitcnt lgkmcnt(0)
    v_lshlrev_b32 v24, 16, v150
    v_lshlrev_b32_e64 v28, 16, v14
    v_and_b32 v25, 0xffff0000, v150
    v_and_b32 v29, 0xffff0000, v14
    v_lshlrev_b32 v26, 16, v151
    v_lshlrev_b32 v30, 16, v15
    v_and_b32 v27, 0xffff0000, v151
    v_and_b32 v31, 0xffff0000, v15
    v_fmac_f32 v28, v16, v24
    v_fmac_f32 v29, v17, v25
    v_fmac_f32 v30, v18, v26
    v_fmac_f32 v31, v19, v27
    v_cvt_pk_bf16_f32 v32, v28, v29
    v_cvt_pk_bf16_f32 v33, v30, v31
    buffer_store_dwordx2 v[32:33], v10, s[64:67], s71 offen sc0 sc1 nt
    s_branch Lfin
Lhelper:
    s_cmp_lg_u32 s3, 7
    s_cbranch_scc1 Lf46
    s_lshl_b32 s70, s0, 5
    s_add_u32 s70, s70, 4096
    s_waitcnt vmcnt(0)
    v_mov_b32 v14, s68
    v_mov_b32 v15, s69
    s_mov_b64 exec, 1
    buffer_store_dwordx2 v[14:15], off, s[4:7], s70 sc1
    s_mov_b64 exec, -1
Lf46:
    s_cmp_le_u32 s71, 195
    s_cbranch_scc1 Lhelp_go
    s_waitcnt vmcnt(0)
    s_branch Lfin
Lhelp_go:
    s_mov_b32 m0, s75
    s_add_u32 s75, s75, 1024
    buffer_load_dwordx4 v5, s[60:63], s74 offen nt lds
    s_add_u32 s74, s74, 7168
    s_mov_b32 m0, s75
    s_add_u32 s75, s75, 1024
    buffer_load_dwordx4 v5, s[60:63], s74 offen nt lds
    s_add_u32 s74, s74, 7168
    s_mov_b32 m0, s75
    s_add_u32 s75, s75, 1024
    buffer_load_dwordx4 v5, s[60:63], s74 offen nt lds
    s_add_u32 s74, s74, 7168
    s_mov_b32 m0, s75
    s_add_u32 s75, s75, 1024
    buffer_load_dwordx4 v5, s[60:63], s74 offen nt lds
    s_add_u32 s74, s74, 7168
    s_mov_b32 m0, s75
    s_add_u32 s75, s75, 1024
    buffer_load_dwordx4 v5, s[60:63], s74 offen nt lds
    s_add_u32 s74, s74, 7168
    s_mov_b32 m0, s75
    s_add_u32 s75, s75, 1024
    buffer_load_dwordx4 v5, s[60:63], s74 offen nt lds
    s_add_u32 s74, s74, 7168
    v_lshrrev_b32 v7, 5, v1
    v_lshlrev_b32 v7, 2, v7
    v_bfe_u32 v8, v1, 2, 2
    v_add_u32 v7, v7, v8
    v_lshlrev_b32 v7, 7, v7
    v_bfe_u32 v8, v1, 3, 1
    v_lshl_add_u32 v7, v8, 6, v7
    v_bfe_u32 v8, v1, 4, 1
    v_lshl_add_u32 v7, v8, 5, v7
    v_and_b32 v8, 3, v1
    v_lshl_add_u32 v10, v8, 3, v7
    s_lshl_b32 s75, s3, 13
    v_add_u32 v10, s75, v10
    v_xor_b32 v11, 64, v10
    s_mul_i32 s74, s73, 229376
    s_lshl_b32 s75, s72, 12
    s_add_u32 s74, s74, s75
    s_add_u32 s74, s74, 2097152
    s_add_u32 s75, s74, 114688
    s_waitcnt vmcnt(0)
    s_nop 0
    ds_read_b64_tr_b16 v[16:17], v10 offset:0
    ds_read_b64_tr_b16 v[18:19], v10 offset:1024
    ds_read_b64_tr_b16 v[20:21], v10 offset:2048
    ds_read_b64_tr_b16 v[22:23], v10 offset:3072
    ds_read_b64_tr_b16 v[24:25], v10 offset:4096
    ds_read_b64_tr_b16 v[26:27], v10 offset:5120
    ds_read_b64_tr_b16 v[28:29], v10 offset:6144
    ds_read_b64_tr_b16 v[30:31], v10 offset:7168
    ds_read_b64_tr_b16 v[32:33], v11 offset:0
    ds_read_b64_tr_b16 v[34:35], v11 offset:1024
    ds_read_b64_tr_b16 v[36:37], v11 offset:2048
    ds_read_b64_tr_b16 v[38:39], v11 offset:3072
    ds_read_b64_tr_b16 v[40:41], v11 offset:4096
    ds_read_b64_tr_b16 v[42:43], v11 offset:5120
    ds_read_b64_tr_b16 v[44:45], v11 offset:6144
    ds_read_b64_tr_b16 v[46:47], v11 offset:7168
    s_waitcnt lgkmcnt(14)
    buffer_store_dwordx4 v[16:19], v3, s[4:7], s74 offen offset:0 sc1
    s_waitcnt lgkmcnt(12)
    buffer_store_dwordx4 v[20:23], v3, s[4:7], s74 offen offset:1024 sc1
    s_waitcnt lgkmcnt(10)
    buffer_store_dwordx4 v[24:27], v3, s[4:7], s74 offen offset:2048 sc1
    s_waitcnt lgkmcnt(8)
    buffer_store_dwordx4 v[28:31], v3, s[4:7], s74 offen offset:3072 sc1
    s_waitcnt lgkmcnt(6)
    buffer_store_dwordx4 v[32:35], v3, s[4:7], s75 offen offset:0 sc1
    s_waitcnt lgkmcnt(4)
    buffer_store_dwordx4 v[36:39], v3, s[4:7], s75 offen offset:1024 sc1
    s_waitcnt lgkmcnt(2)
    buffer_store_dwordx4 v[40:43], v3, s[4:7], s75 offen offset:2048 sc1
    s_waitcnt lgkmcnt(0)
    buffer_store_dwordx4 v[44:47], v3, s[4:7], s75 offen offset:3072 sc1
    s_mul_i32 s74, s73, 28
    s_add_u32 s74, s74, s72
    s_lshl_b32 s74, s74, 5
    s_add_u32 s74, s74, 12288
    s_waitcnt vmcnt(0)
    v_mov_b32 v8, s68
    v_mov_b32 v9, s69
    s_mov_b64 exec, 1
    buffer_store_dwordx2 v[8:9], off, s[4:7], s74 sc1
    s_mov_b64 exec, -1
Lfin:
Lend:
s_endpgm
.section .rodata,"a"
.p2align 6
.amdhsa_kernel recurrent_scan__ssm_conv_s4__glu_gated_glu__prompt_kernel
  .amdhsa_next_free_vgpr 256
  .amdhsa_next_free_sgpr 102
  .amdhsa_accum_offset 256
  .amdhsa_group_segment_fixed_size 0
  .amdhsa_kernarg_size 128
  .amdhsa_user_sgpr_count 2
  .amdhsa_user_sgpr_kernarg_segment_ptr 1
  .amdhsa_system_sgpr_workgroup_id_x 1
.end_amdhsa_kernel
```
